```python
import torch

def _softmax(x, axis=-1):
    return torch.softmax(x, dim=axis)
def _gelu(x):
    return torch.nn.functional.gelu(x, approximate="tanh")
def _silu(x):
    return torch.nn.functional.silu(x)
def _sigmoid(x):
    return torch.sigmoid(x)
def _layernorm(x, axis=-1, eps=1e-5):
    m = x.mean(dim=axis, keepdim=True)
    v = x.var(dim=axis, keepdim=True, unbiased=False)
    return (x - m) / torch.sqrt(v + eps)
def _scatter_add(tgt, idx, src, axis=0):
    return tgt.clone().index_add_(axis, idx, src)
def _segment_sum(src, seg, n):
    out = torch.zeros((n,) + src.shape[1:], dtype=src.dtype)
    return out.index_add_(0, seg, src)
def _pad(x, pw):
    flat = tuple(v for pair in reversed(pw) for v in pair)
    return torch.nn.functional.pad(x, flat)

kernel_name = 'sequential_preLN__sliding_block_cached__swiglu_ffn__decode'

def setup_inputs():

    _w = (lambda a: (lambda t: t.to(torch.bfloat16) if t.is_floating_point() else t)(torch.as_tensor(a)))
    def _A_setup():
        B, Sq, D = 1, 1, 512
        Hq, Hkv, Sk, Dh = 32, 32, 32768, 128
        assert Hq % Hkv == 0, (Hq, Hkv)
        return {
            "x": _w((lambda *s: torch.randn(*s, dtype=torch.bfloat16) * 0.05)(B, Sq, D)),
            "k_cache": _w((lambda *s: torch.randn(*s, dtype=torch.bfloat16) * 3.2)(B, Hkv, Sk, Dh)),
            "v_cache": _w((lambda *s: torch.randn(*s, dtype=torch.bfloat16) * 0.4)(B, Hkv, Sk, Dh)),
            "wq": _w((lambda *s: torch.randn(*s, dtype=torch.bfloat16) * 3.2)(D, Hq * Dh) * (D ** -0.5)),
            "wo": _w((lambda *s: torch.randn(*s, dtype=torch.bfloat16) * 0.4)(Hq * Dh, D) * ((Hq * Dh) ** -0.5)),
        }
    _A_in = _A_setup()

    def _B_setup():
        B, S, D, F = 1, 1, 512, 1376
        return {
            "x": _w((lambda *s: torch.randn(*s, dtype=torch.bfloat16) * 0.05)(B, S, D)),
            "w_gate": _w((lambda *s: torch.randn(*s, dtype=torch.bfloat16) * 0.05)(D, F)),
            "w_up": _w((lambda *s: torch.randn(*s, dtype=torch.bfloat16) * 0.05)(D, F)),
            "w_down": _w((lambda *s: torch.randn(*s, dtype=torch.bfloat16) * 0.05)(F, D)),
        }
    _B_in = _B_setup()

    return {
        "A_x": _A_in["x"],
        "A_k_cache": _A_in["k_cache"],
        "A_v_cache": _A_in["v_cache"],
        "A_wq": _A_in["wq"],
        "A_wo": _A_in["wo"],
        "B_x": _B_in["x"],
        "B_w_gate": _B_in["w_gate"],
        "B_w_up": _B_in["w_up"],
        "B_w_down": _B_in["w_down"],
    }

def reference(A_x, A_k_cache, A_v_cache, A_wq, A_wo, B_x, B_w_gate, B_w_up, B_w_down):
    def _A_ref(x, k_cache, v_cache, wq, wo):
        B, Sq, D = x.shape
        Hq, Dh = 32, 128
        Hkv, Sk = k_cache.shape[1], k_cache.shape[2]
        W = min(4096, max(256, Sk // 4))
        rep = Hq // Hkv
        q = (lambda x, *d: x.permute(*d))((x @ wq).reshape(B, Sq, Hq, Dh), 0, 2, 1, 3)
        k = (lambda x, n, axis: torch.repeat_interleave(x, n, dim=axis))(k_cache[:, :, Sk - W:, :], rep, axis=1)
        v = (lambda x, n, axis: torch.repeat_interleave(x, n, dim=axis))(v_cache[:, :, Sk - W:, :], rep, axis=1)
        scores = torch.einsum("bhqd,bhkd->bhqk", q, k) * (Dh ** -0.5)
        p = _softmax(scores, axis=-1)
        o = torch.einsum("bhqk,bhkd->bhqd", p, v)
        return (lambda x, *d: x.permute(*d))(o, 0, 2, 1, 3).reshape(B, Sq, Hq * Dh) @ wo

    def _B_ref(x, w_gate, w_up, w_down):
        g = _silu(x @ w_gate)
        u = x @ w_up
        return (g * u) @ w_down

    x = A_x
    h = x + _A_ref(_layernorm(x, axis=-1), A_k_cache, A_v_cache, A_wq, A_wo)
    h2 = h + _B_ref(_layernorm(h, axis=-1), B_w_gate, B_w_up, B_w_down)
    return h2
```

```asm
; @launch grid=(256,1,1) block=(576,1,1) lds=19968
.amdgcn_target "amdgcn-amd-amdhsa--gfx950"
.text
.globl sequential_preLN__sliding_block_cached__swiglu_ffn__decode_kernel
.p2align 8
.type sequential_preLN__sliding_block_cached__swiglu_ffn__decode_kernel,@function
sequential_preLN__sliding_block_cached__swiglu_ffn__decode_kernel:
    s_load_dwordx2 s[32:33], s[0:1], 8
    s_cmpk_ge_u32 s2, 256
    s_cbranch_scc1 L_end
    v_readfirstlane_b32 s5, v0
    s_cmpk_lt_u32 s5, 64
    s_cbranch_scc1 L_helper_args
    v_subrev_u32 v0, 64, v0
    s_getpc_b64 s[82:83]
L_pc:
    v_lshlrev_b32 v24, 5, v0
    v_min_u32 v24, L_last-L_pc, v24
    global_load_dword v3, v24, s[82:83]
    s_and_b32 s3, s2, 31
    s_lshr_b32 s4, s2, 5
    v_lshlrev_b32 v2, 4, v0
    s_lshl_b32 s77, s2, 7
    s_and_b32 s77, s77, 0xc00
    v_xor_b32 v2, s77, v2
    s_lshl3_add_u32 s76, s3, 7
    s_lshl_b32 s76, s76, 20
    s_and_b32 s77, s4, 1
    s_lshl_b32 s77, s77, 15
    s_add_u32 s76, s76, s77
    s_lshr_b32 s77, s4, 1
    s_lshl_b32 s77, s77, 17
    s_add_u32 s76, s76, s77
    s_lshl_b32 s60, s5, 7
    s_and_b32 s60, s60, 0x6000
    s_xor_b32 s61, s60, 0x2000
    s_xor_b32 s62, s60, 0x4000
    s_xor_b32 s63, s60, 0x6000
    s_mov_b32 s35, 0x20000
    s_mov_b32 s34, 0x98000
    s_waitcnt lgkmcnt(0)
    s_add_u32 s32, s32, s76
    s_addc_u32 s33, s33, 0
    buffer_load_dwordx4 v[48:51], v2, s[32:35], s60 offen nt
    buffer_load_dwordx4 v[52:55], v2, s[32:35], s61 offen nt
    buffer_load_dwordx4 v[56:59], v2, s[32:35], s62 offen nt
    buffer_load_dwordx4 v[60:63], v2, s[32:35], s63 offen nt
    s_branch L_stream
L_helper_args:
    s_load_dwordx16 s[8:23], s[0:1], 0
    s_load_dwordx8 s[24:31], s[0:1], 64
    s_branch L_helper0
.p2align 8
L_helper0:
    s_setprio 1
    v_lshlrev_b32 v24, 3, v0
    v_mov_b32 v30, -1
    v_mov_b32 v31, -1
    ds_write_b64 v24, v[30:31]
    s_and_b32 s3, s2, 31
    s_lshr_b32 s4, s2, 5
    v_lshlrev_b32 v22, 4, v0
    v_lshrrev_b32 v24, 4, v0
    v_and_b32 v25, 15, v0
    s_lshl_b32 s77, s4, 6
    v_add_u32 v24, s77, v24
    v_lshl_add_u32 v23, v25, 2, v24
    v_lshlrev_b32 v23, 1, v23
    v_lshlrev_b32 v3, 13, v24
    v_lshl_add_u32 v3, v25, 4, v3
    s_lshl_b32 s76, s3, 8
    s_mov_b32 s77, 0x8000
    s_mov_b32 s42, 0x400000
    s_mov_b32 s43, 0x20000
    s_waitcnt lgkmcnt(0)
    s_barrier
    global_load_dwordx4 v[28:31], v22, s[8:9]
    global_load_ushort v27, v23, s[8:9]
    s_mov_b64 s[40:41], s[14:15]
    buffer_load_dwordx4 v[48:51], v3, s[40:43], s76 offen nt
    s_add_u32 s76, s76, s77
    buffer_load_dwordx4 v[52:55], v3, s[40:43], s76 offen nt
    s_add_u32 s76, s76, s77
    buffer_load_dwordx4 v[56:59], v3, s[40:43], s76 offen nt
    s_add_u32 s76, s76, s77
    buffer_load_dwordx4 v[60:63], v3, s[40:43], s76 offen nt
    s_add_u32 s76, s76, s77
    buffer_load_dwordx4 v[64:67], v3, s[40:43], s76 offen nt
    s_add_u32 s76, s76, s77
    buffer_load_dwordx4 v[68:71], v3, s[40:43], s76 offen nt
    s_add_u32 s76, s76, s77
    buffer_load_dwordx4 v[72:75], v3, s[40:43], s76 offen nt
    s_add_u32 s76, s76, s77
    buffer_load_dwordx4 v[76:79], v3, s[40:43], s76 offen nt
    s_add_u32 s76, s76, s77
    buffer_load_dwordx4 v[80:83], v3, s[40:43], s76 offen nt
    s_add_u32 s76, s76, s77
    buffer_load_dwordx4 v[84:87], v3, s[40:43], s76 offen nt
    s_add_u32 s76, s76, s77
    buffer_load_dwordx4 v[88:91], v3, s[40:43], s76 offen nt
    s_add_u32 s76, s76, s77
    buffer_load_dwordx4 v[92:95], v3, s[40:43], s76 offen nt
    s_add_u32 s76, s76, s77
    buffer_load_dwordx4 v[96:99], v3, s[40:43], s76 offen nt
    s_add_u32 s76, s76, s77
    buffer_load_dwordx4 v[100:103], v3, s[40:43], s76 offen nt
    s_add_u32 s76, s76, s77
    buffer_load_dwordx4 v[104:107], v3, s[40:43], s76 offen nt
    s_add_u32 s76, s76, s77
    buffer_load_dwordx4 v[108:111], v3, s[40:43], s76 offen nt
    s_mov_b32 s5, -1
    s_branch L_helper
L_stream:
    s_load_dwordx16 s[8:23], s[0:1], 0
    s_load_dwordx8 s[24:31], s[0:1], 64
    s_barrier
    s_xor_b32 s64, s60, 0x10000
    s_xor_b32 s65, s60, 0x12000
    s_xor_b32 s66, s60, 0x14000
    s_xor_b32 s67, s60, 0x16000
    s_xor_b32 s68, s60, 0x80000
    s_xor_b32 s69, s60, 0x82000
    s_xor_b32 s70, s60, 0x84000
    s_xor_b32 s71, s60, 0x86000
    s_xor_b32 s72, s60, 0x90000
    s_xor_b32 s73, s60, 0x92000
    s_xor_b32 s74, s60, 0x94000
    s_xor_b32 s75, s60, 0x96000
    s_lshr_b32 s5, s5, 6
    s_sub_u32 s5, s5, 1
    s_mov_b32 s7, 1048576
    s_lshl3_add_u32 s81, s3, s4
    s_getreg_b32 s84, hwreg(HW_REG_XCC_ID, 0, 3)
    v_and_b32 v1, 63, v0
    s_waitcnt lgkmcnt(0)
    s_add_u32 s36, s12, s76
    s_addc_u32 s37, s13, 0
    s_mov_b32 s38, 622592
    s_mov_b32 s39, 0x20000
    s_mov_b32 s44, s8
    s_mov_b32 s45, s9
    s_mov_b32 s46, 1024
    s_mov_b32 s47, 0x20000
    v_and_b32 v32, 8, v0
    v_mov_b32 v33, 0x0100
    v_mov_b32 v34, 0x0302
    v_cmp_ne_u32 vcc, 0, v32
    s_nop 1
    v_cndmask_b32 v33, v33, v34, vcc
    v_or_b32 v34, 0x0c0c0000, v33
    v_lshlrev_b32 v33, 16, v33
    v_or_b32 v33, 0x0c0c, v33
    v_and_b32 v32, 1, v0
    v_cmp_ne_u32 vcc, 0, v32
    s_nop 1
    v_cndmask_b32 v33, v34, v33, vcc
    v_bfe_u32 v32, v0, 1, 2
    v_mov_b32 v34, 0x0c0c0c0c
    v_cmp_eq_u32 vcc, 0, v32
    s_nop 1
    v_cndmask_b32 v4, v34, v33, vcc
    v_cmp_eq_u32 vcc, 1, v32
    s_nop 1
    v_cndmask_b32 v5, v34, v33, vcc
    v_cmp_eq_u32 vcc, 2, v32
    s_nop 1
    v_cndmask_b32 v6, v34, v33, vcc
    v_cmp_eq_u32 vcc, 3, v32
    s_nop 1
    v_cndmask_b32 v7, v34, v33, vcc
    v_bfe_u32 v144, v0, 4, 2
    v_and_b32 v145, 7, v0
    v_bfe_u32 v146, v0, 3, 1
    v_and_b32 v22, 15, v0
    v_lshlrev_b32 v22, 4, v22
    v_lshlrev_b32 v147, 4, v0
    v_lshlrev_b32 v148, 4, v1
    v_and_b32 v32, 1, v144
    v_lshlrev_b32 v149, 1, v22
    v_lshl_add_u32 v149, v32, 4, v149
    v_lshrrev_b32 v32, 1, v144
    v_lshl_add_u32 v149, v32, 3, v149
    s_lshl_b32 s85, s81, 9
    v_mov_b32 v46, 1
    v_mov_b32 v47, 0
    v_mov_b32 v164, 0xff
    v_mov_b32 v165, 0
    v_lshl_add_u32 v151, v144, 3, v145
    s_waitcnt vmcnt(3)
    buffer_load_dwordx4 v[64:67], v2, s[32:35], s64 offen nt
    s_waitcnt vmcnt(3)
    buffer_load_dwordx4 v[68:71], v2, s[32:35], s65 offen nt
    s_waitcnt vmcnt(3)
    buffer_load_dwordx4 v[72:75], v2, s[32:35], s66 offen nt
    s_waitcnt vmcnt(3)
    buffer_load_dwordx4 v[76:79], v2, s[32:35], s67 offen nt
    s_load_dword s6, s[30:31], 557060
    s_mov_b32 s48, s30
    s_mov_b32 s49, s31
    s_mov_b32 s50, 2097152
    s_mov_b32 s51, 0x20000
    s_and_b32 s77, s3, 7
    s_lshl_b32 s79, s77, 3
    s_mov_b32 s76, 0x120c0600
    s_mov_b32 s77, 0x26211c17
    s_lshr_b64 s[76:77], s[76:77], s79
    s_and_b32 s88, s76, 0xff
    s_lshr_b32 s79, s79, 1
    s_lshr_b32 s94, 0x55555666, s79
    s_and_b32 s94, s94, 15
    s_lshr_b32 s89, s2, 3
    s_sub_u32 s77, s89, 8
    s_add_u32 s79, s77, s88
    s_cmp_lt_u32 s77, s94
    s_cselect_b32 s80, s79, 63
    s_add_u32 s79, s89, 64
    s_cmp_lt_u32 s89, 8
    s_cselect_b32 s80, s79, s80
    s_mov_b32 s83, 0
    v_mov_b32 v33, 0
    s_cmp_lt_u32 s4, 4
    s_cselect_b32 s90, 1, 0x01010101
    s_cselect_b32 s91, 0, 0x01010101
    s_and_b32 s78, s4, 3
    s_lshl2_add_u32 s77, s3, s78
    s_lshl_b32 s77, s77, 15
    v_add_u32 v32, s77, v2
    v_lshl_add_u64 v[162:163], v[32:33], 0, s[16:17]
    s_cmp_lt_u32 s80, 43
    s_cbranch_scc1 L_addr_ffn
    s_cmp_lt_u32 s80, 64
    s_cbranch_scc1 L_addr_fetch
    v_lshl_add_u32 v32, v144, 4, v146
    s_and_b32 s77, s3, 7
    s_lshl_b32 s77, s77, 17
    s_lshr_b32 s78, s5, 1
    s_lshl_b32 s78, s78, 20
    s_add_u32 s77, s77, s78
    s_and_b32 s78, s5, 1
    s_lshl_b32 s78, s78, 16
    s_add_u32 s77, s77, s78
    s_and_b32 s78, s80, 7
    s_lshl_b32 s78, s78, 7
    s_add_u32 s77, s77, s78
    v_lshlrev_b32 v32, 10, v32
    v_lshl_add_u32 v32, v145, 4, v32
    v_add_u32 v32, s77, v32
    v_lshl_add_u64 v[44:45], v[32:33], 0, s[16:17]
    s_mov_b32 s82, 2048
    s_branch L_addr_done
L_addr_ffn:
    v_and_b32 v32, 0x1f8, v0
    v_mul_u32_u24 v32, 2752, v32
    v_and_b32 v34, 3, v0
    v_lshl_add_u32 v32, v34, 4, v32
    s_lshl_b32 s77, s80, 6
    s_branch L_addr_gu
L_addr_fetch:
    s_lshl_b32 s77, s94, 6
    s_sub_u32 s77, s77, 4
    v_and_b32 v32, 3, v0
    v_lshlrev_b32 v32, 7, v32
    v_min_u32 v32, s77, v32
    v_bfe_u32 v34, v0, 3, 2
    v_bfe_u32 v35, v0, 5, 1
    v_lshl_add_u32 v34, v35, 3, v34
    v_mul_u32_u24 v34, 2752, v34
    v_add_u32 v32, v32, v34
    s_and_b32 s78, s89, 15
    s_mul_i32 s77, s78, 44032
    s_lshl_b32 s79, s88, 6
    s_add_u32 s77, s77, s79
L_addr_gu:
    v_add_u32 v32, s77, v32
    v_lshl_add_u64 v[44:45], v[32:33], 0, s[20:21]
    s_mov_b32 exec_lo, 0xf0f0f0f0
    s_mov_b32 exec_hi, 0xf0f0f0f0
    v_lshl_add_u64 v[44:45], v[32:33], 0, s[22:23]
    s_mov_b64 exec, -1
    s_mov_b32 s82, 2752
L_addr_done:
    s_waitcnt vmcnt(3)
    buffer_load_dwordx4 v[80:83], v2, s[32:35], s68 offen nt
    s_waitcnt vmcnt(3)
    buffer_load_dwordx4 v[84:87], v2, s[32:35], s69 offen nt
    s_waitcnt vmcnt(3)
    buffer_load_dwordx4 v[88:91], v2, s[32:35], s70 offen nt
    s_waitcnt vmcnt(3)
    buffer_load_dwordx4 v[92:95], v2, s[32:35], s71 offen nt
    s_waitcnt lgkmcnt(0)
    s_add_u32 s92, s6, 1
    s_and_b32 s92, s92, 0xff
    s_mov_b32 s19, s92
    s_bfe_u32 s77, s6, 0x80008
    s_add_u32 s77, s77, 1
    s_cmp_lt_u32 s77, 255
    s_cselect_b32 s77, s77, 0
    s_lshl_b32 s77, s77, 8
    s_or_b32 s19, s19, s77
    s_bfe_u32 s77, s6, 0x80010
    s_add_u32 s77, s77, 1
    s_cmp_lt_u32 s77, 253
    s_cselect_b32 s77, s77, 0
    s_lshl_b32 s77, s77, 16
    s_or_b32 s19, s19, s77
    s_bfe_u32 s77, s6, 0x80018
    s_add_u32 s77, s77, 1
    s_cmp_lt_u32 s77, 251
    s_cselect_b32 s77, s77, 0
    s_lshl_b32 s77, s77, 24
    s_or_b32 s19, s19, s77
    s_and_b32 s6, s19, -8
    s_waitcnt vmcnt(3)
    buffer_load_dwordx4 v[96:99], v2, s[32:35], s72 offen nt
    s_waitcnt vmcnt(3)
    buffer_load_dwordx4 v[100:103], v2, s[32:35], s73 offen nt
    s_waitcnt vmcnt(3)
    buffer_load_dwordx4 v[104:107], v2, s[32:35], s74 offen nt
    s_waitcnt vmcnt(3)
    buffer_load_dwordx4 v[108:111], v2, s[32:35], s75 offen nt
    s_waitcnt vmcnt(3)
    buffer_load_dwordx4 v[112:115], v2, s[36:39], s60 offen nt
    s_waitcnt vmcnt(3)
    buffer_load_dwordx4 v[116:119], v2, s[36:39], s61 offen nt
    s_waitcnt vmcnt(3)
    buffer_load_dwordx4 v[120:123], v2, s[36:39], s62 offen nt
    s_waitcnt vmcnt(3)
    buffer_load_dwordx4 v[124:127], v2, s[36:39], s63 offen nt
L_wait_q:
    ds_read_b128 v[40:43], v22 offset:0
    s_waitcnt lgkmcnt(0)
    v_max3_u32 v21, v40, v41, v42
    v_max_u32 v21, v21, v43
    v_cmp_eq_u32 vcc, -1, v21
    s_cbranch_vccnz L_wait_q_again
    v_dot2_f32_bf16 v24, v48, v40, 0
    v_dot2_f32_bf16 v25, v52, v40, 0
    v_dot2_f32_bf16 v26, v56, v40, 0
    v_dot2_f32_bf16 v27, v60, v40, 0
    v_dot2_f32_bf16 v28, v64, v40, 0
    v_dot2_f32_bf16 v29, v68, v40, 0
    v_dot2_f32_bf16 v30, v72, v40, 0
    v_dot2_f32_bf16 v31, v76, v40, 0
    v_dot2_f32_bf16 v32, v80, v40, 0
    v_dot2_f32_bf16 v33, v84, v40, 0
    v_dot2_f32_bf16 v34, v88, v40, 0
    v_dot2_f32_bf16 v35, v92, v40, 0
    v_dot2_f32_bf16 v36, v96, v40, 0
    v_dot2_f32_bf16 v37, v100, v40, 0
    v_dot2_f32_bf16 v38, v104, v40, 0
    v_dot2_f32_bf16 v39, v108, v40, 0
    v_dot2_f32_bf16 v24, v49, v41, v24
    v_dot2_f32_bf16 v25, v53, v41, v25
    v_dot2_f32_bf16 v26, v57, v41, v26
    v_dot2_f32_bf16 v27, v61, v41, v27
    v_dot2_f32_bf16 v28, v65, v41, v28
    v_dot2_f32_bf16 v29, v69, v41, v29
    v_dot2_f32_bf16 v30, v73, v41, v30
    v_dot2_f32_bf16 v31, v77, v41, v31
    v_dot2_f32_bf16 v32, v81, v41, v32
    v_dot2_f32_bf16 v33, v85, v41, v33
    v_dot2_f32_bf16 v34, v89, v41, v34
    v_dot2_f32_bf16 v35, v93, v41, v35
    v_dot2_f32_bf16 v36, v97, v41, v36
    v_dot2_f32_bf16 v37, v101, v41, v37
    v_dot2_f32_bf16 v38, v105, v41, v38
    v_dot2_f32_bf16 v39, v109, v41, v39
    v_dot2_f32_bf16 v24, v50, v42, v24
    v_dot2_f32_bf16 v25, v54, v42, v25
    v_dot2_f32_bf16 v26, v58, v42, v26
    v_dot2_f32_bf16 v27, v62, v42, v27
    v_dot2_f32_bf16 v28, v66, v42, v28
    v_dot2_f32_bf16 v29, v70, v42, v29
    v_dot2_f32_bf16 v30, v74, v42, v30
    v_dot2_f32_bf16 v31, v78, v42, v31
    v_dot2_f32_bf16 v32, v82, v42, v32
    v_dot2_f32_bf16 v33, v86, v42, v33
    v_dot2_f32_bf16 v34, v90, v42, v34
    v_dot2_f32_bf16 v35, v94, v42, v35
    v_dot2_f32_bf16 v36, v98, v42, v36
    v_dot2_f32_bf16 v37, v102, v42, v37
    v_dot2_f32_bf16 v38, v106, v42, v38
    v_dot2_f32_bf16 v39, v110, v42, v39
    v_dot2_f32_bf16 v24, v51, v43, v24
    v_dot2_f32_bf16 v25, v55, v43, v25
    v_dot2_f32_bf16 v26, v59, v43, v26
    v_dot2_f32_bf16 v27, v63, v43, v27
    v_dot2_f32_bf16 v28, v67, v43, v28
    v_dot2_f32_bf16 v29, v71, v43, v29
    v_dot2_f32_bf16 v30, v75, v43, v30
    v_dot2_f32_bf16 v31, v79, v43, v31
    v_dot2_f32_bf16 v32, v83, v43, v32
    v_dot2_f32_bf16 v33, v87, v43, v33
    v_dot2_f32_bf16 v34, v91, v43, v34
    v_dot2_f32_bf16 v35, v95, v43, v35
    v_dot2_f32_bf16 v36, v99, v43, v36
    v_dot2_f32_bf16 v37, v103, v43, v37
    v_dot2_f32_bf16 v38, v107, v43, v38
    v_dot2_f32_bf16 v39, v111, v43, v39
    v_add_f32_dpp v24, v24, v24 row_ror:8 row_mask:0xf bank_mask:0x3
    v_add_f32_dpp v25, v25, v25 row_ror:8 row_mask:0xf bank_mask:0x3
    v_add_f32_dpp v26, v26, v26 row_ror:8 row_mask:0xf bank_mask:0x3
    v_add_f32_dpp v27, v27, v27 row_ror:8 row_mask:0xf bank_mask:0x3
    v_add_f32_dpp v28, v28, v28 row_ror:8 row_mask:0xf bank_mask:0x3
    v_add_f32_dpp v29, v29, v29 row_ror:8 row_mask:0xf bank_mask:0x3
    v_add_f32_dpp v30, v30, v30 row_ror:8 row_mask:0xf bank_mask:0x3
    v_add_f32_dpp v31, v31, v31 row_ror:8 row_mask:0xf bank_mask:0x3
    v_add_f32_dpp v24, v32, v32 row_ror:8 row_mask:0xf bank_mask:0xc
    v_add_f32_dpp v25, v33, v33 row_ror:8 row_mask:0xf bank_mask:0xc
    v_add_f32_dpp v26, v34, v34 row_ror:8 row_mask:0xf bank_mask:0xc
    v_add_f32_dpp v27, v35, v35 row_ror:8 row_mask:0xf bank_mask:0xc
    v_add_f32_dpp v28, v36, v36 row_ror:8 row_mask:0xf bank_mask:0xc
    v_add_f32_dpp v29, v37, v37 row_ror:8 row_mask:0xf bank_mask:0xc
    v_add_f32_dpp v30, v38, v38 row_ror:8 row_mask:0xf bank_mask:0xc
    v_add_f32_dpp v31, v39, v39 row_ror:8 row_mask:0xf bank_mask:0xc
    v_add_f32_dpp v24, v24, v24 row_half_mirror row_mask:0xf bank_mask:0x5
    v_add_f32_dpp v25, v25, v25 row_half_mirror row_mask:0xf bank_mask:0x5
    v_add_f32_dpp v26, v26, v26 row_half_mirror row_mask:0xf bank_mask:0x5
    v_add_f32_dpp v27, v27, v27 row_half_mirror row_mask:0xf bank_mask:0x5
    v_add_f32_dpp v24, v28, v28 row_half_mirror row_mask:0xf bank_mask:0xa
    v_add_f32_dpp v25, v29, v29 row_half_mirror row_mask:0xf bank_mask:0xa
    v_add_f32_dpp v26, v30, v30 row_half_mirror row_mask:0xf bank_mask:0xa
    v_add_f32_dpp v27, v31, v31 row_half_mirror row_mask:0xf bank_mask:0xa
    v_add_f32_dpp v24, v24, v24 quad_perm:[1,0,3,2] row_mask:0xf bank_mask:0xf
    v_add_f32_dpp v25, v25, v25 quad_perm:[1,0,3,2] row_mask:0xf bank_mask:0xf
    v_add_f32_dpp v26, v26, v26 quad_perm:[1,0,3,2] row_mask:0xf bank_mask:0xf
    v_add_f32_dpp v27, v27, v27 quad_perm:[1,0,3,2] row_mask:0xf bank_mask:0xf
    s_mov_b32 vcc_lo, 0xaaaaaaaa
    s_mov_b32 vcc_hi, 0xaaaaaaaa
    v_cndmask_b32 v24, v24, v25, vcc
    v_cndmask_b32 v26, v26, v27, vcc
    s_nop 0
    v_add_f32_dpp v24, v24, v24 quad_perm:[2,3,0,1] row_mask:0xf bank_mask:0xf
    v_add_f32_dpp v26, v26, v26 quad_perm:[2,3,0,1] row_mask:0xf bank_mask:0xf
    s_mov_b32 vcc_lo, 0xcccccccc
    s_mov_b32 vcc_hi, 0xcccccccc
    v_cndmask_b32 v24, v24, v26, vcc
    v_cvt_pk_bf16_f32 v24, v24, v24
    v_lshlrev_b32 v24, 16, v24
    v_mul_f32 v24, 0x3db504f3, v24
    v_cvt_pk_bf16_f32 v24, v24, v24
    v_lshlrev_b32 v24, 16, v24
    v_mov_b32 v26, v24
    s_nop 1
    v_max_f32_dpp v26, v26, v26 quad_perm:[1,0,3,2] row_mask:0xf bank_mask:0xf
    s_nop 1
    v_max_f32_dpp v26, v26, v26 quad_perm:[2,3,0,1] row_mask:0xf bank_mask:0xf
    s_nop 1
    v_max_f32_dpp v26, v26, v26 row_half_mirror row_mask:0xf bank_mask:0xf
    s_nop 1
    v_max_f32_dpp v26, v26, v26 row_mirror row_mask:0xf bank_mask:0xf
    s_nop 1
    v_max_f32_dpp v26, v26, v26 row_bcast:15 row_mask:0xa bank_mask:0xf
    s_nop 1
    v_max_f32_dpp v26, v26, v26 row_bcast:31 row_mask:0xc bank_mask:0xf
    s_nop 0
    v_readlane_b32 s18, v26, 63
    s_nop 1
    v_subrev_f32 v24, s18, v24
    v_mul_f32 v24, 0x3fb8aa3b, v24
    v_exp_f32 v24, v24
    s_nop 0
    v_cvt_pk_bf16_f32 v26, v24, v24
    v_lshlrev_b32 v26, 16, v26
    v_sub_f32 v26, v24, v26
    v_cvt_pk_bf16_f32 v20, v24, v26
    v_mov_b32 v26, v24
    s_nop 1
    v_add_f32_dpp v26, v26, v26 quad_perm:[1,0,3,2] row_mask:0xf bank_mask:0xf
    s_nop 1
    v_add_f32_dpp v26, v26, v26 quad_perm:[2,3,0,1] row_mask:0xf bank_mask:0xf
    s_nop 1
    v_add_f32_dpp v26, v26, v26 row_half_mirror row_mask:0xf bank_mask:0xf
    s_nop 1
    v_add_f32_dpp v26, v26, v26 row_mirror row_mask:0xf bank_mask:0xf
    s_nop 1
    v_add_f32_dpp v26, v26, v26 row_bcast:15 row_mask:0xa bank_mask:0xf
    s_nop 1
    v_add_f32_dpp v26, v26, v26 row_bcast:31 row_mask:0xc bank_mask:0xf
    s_nop 0
    v_readlane_b32 s78, v26, 63
    v_mov_b32 v26, s18
    s_nop 0
    v_mov_b32 v27, s78
    s_lshl_b32 s77, s5, 3
    v_mov_b32 v28, s77
    s_mov_b64 exec, 1
    ds_write_b64 v28, v[26:27] offset:256
    s_mov_b64 exec, -1
    v_mov_b32_dpp v21, v20 row_newbcast:0 row_mask:0xf bank_mask:0xf
    v_perm_b32 v8, v21, v21, v4
    v_perm_b32 v9, v21, v21, v5
    v_perm_b32 v10, v21, v21, v6
    v_perm_b32 v11, v21, v21, v7
    s_waitcnt vmcnt(3)
    buffer_load_dwordx4 v[128:131], v2, s[36:39], s64 offen nt
    s_waitcnt vmcnt(3)
    buffer_load_dwordx4 v[132:135], v2, s[36:39], s65 offen nt
    s_waitcnt vmcnt(3)
    buffer_load_dwordx4 v[136:139], v2, s[36:39], s66 offen nt
    s_waitcnt vmcnt(3)
    buffer_load_dwordx4 v[140:143], v2, s[36:39], s67 offen nt
    v_mfma_f32_16x16x32_bf16 v[16:19], v[8:11], v[112:115], 0
    v_mov_b32_dpp v21, v20 row_newbcast:1 row_mask:0xf bank_mask:0xf
    v_perm_b32 v12, v21, v21, v4
    v_perm_b32 v13, v21, v21, v5
    v_perm_b32 v14, v21, v21, v6
    v_perm_b32 v15, v21, v21, v7
    s_nop 1
    v_mfma_f32_16x16x32_bf16 v[16:19], v[12:15], v[116:119], v[16:19]
    v_mov_b32_dpp v21, v20 row_newbcast:2 row_mask:0xf bank_mask:0xf
    v_perm_b32 v8, v21, v21, v4
    v_perm_b32 v9, v21, v21, v5
    v_perm_b32 v10, v21, v21, v6
    v_perm_b32 v11, v21, v21, v7
    s_nop 1
    v_mfma_f32_16x16x32_bf16 v[16:19], v[8:11], v[120:123], v[16:19]
    v_mov_b32_dpp v21, v20 row_newbcast:3 row_mask:0xf bank_mask:0xf
    v_perm_b32 v12, v21, v21, v4
    v_perm_b32 v13, v21, v21, v5
    v_perm_b32 v14, v21, v21, v6
    v_perm_b32 v15, v21, v21, v7
    s_nop 1
    v_mfma_f32_16x16x32_bf16 v[16:19], v[12:15], v[124:127], v[16:19]
    v_mov_b32_dpp v21, v20 row_newbcast:4 row_mask:0xf bank_mask:0xf
    v_perm_b32 v8, v21, v21, v4
    v_perm_b32 v9, v21, v21, v5
    v_perm_b32 v10, v21, v21, v6
    v_perm_b32 v11, v21, v21, v7
    s_waitcnt vmcnt(3)
    buffer_load_dwordx4 v[64:67], v2, s[36:39], s68 offen nt
    s_waitcnt vmcnt(3)
    buffer_load_dwordx4 v[68:71], v2, s[36:39], s69 offen nt
    s_waitcnt vmcnt(3)
    buffer_load_dwordx4 v[72:75], v2, s[36:39], s70 offen nt
    s_waitcnt vmcnt(3)
    buffer_load_dwordx4 v[76:79], v2, s[36:39], s71 offen nt
    v_mfma_f32_16x16x32_bf16 v[16:19], v[8:11], v[128:131], v[16:19]
    v_mov_b32_dpp v21, v20 row_newbcast:5 row_mask:0xf bank_mask:0xf
    v_perm_b32 v12, v21, v21, v4
    v_perm_b32 v13, v21, v21, v5
    v_perm_b32 v14, v21, v21, v6
    v_perm_b32 v15, v21, v21, v7
    s_nop 1
    v_mfma_f32_16x16x32_bf16 v[16:19], v[12:15], v[132:135], v[16:19]
    v_mov_b32_dpp v21, v20 row_newbcast:6 row_mask:0xf bank_mask:0xf
    v_perm_b32 v8, v21, v21, v4
    v_perm_b32 v9, v21, v21, v5
    v_perm_b32 v10, v21, v21, v6
    v_perm_b32 v11, v21, v21, v7
    s_nop 1
    v_mfma_f32_16x16x32_bf16 v[16:19], v[8:11], v[136:139], v[16:19]
    v_mov_b32_dpp v21, v20 row_newbcast:7 row_mask:0xf bank_mask:0xf
    v_perm_b32 v12, v21, v21, v4
    v_perm_b32 v13, v21, v21, v5
    v_perm_b32 v14, v21, v21, v6
    v_perm_b32 v15, v21, v21, v7
    s_nop 1
    v_mfma_f32_16x16x32_bf16 v[16:19], v[12:15], v[140:143], v[16:19]
    v_mov_b32_dpp v21, v20 row_newbcast:8 row_mask:0xf bank_mask:0xf
    v_perm_b32 v8, v21, v21, v4
    v_perm_b32 v9, v21, v21, v5
    v_perm_b32 v10, v21, v21, v6
    v_perm_b32 v11, v21, v21, v7
    s_waitcnt vmcnt(3)
    buffer_load_dwordx4 v[80:83], v2, s[36:39], s72 offen nt
    s_waitcnt vmcnt(3)
    buffer_load_dwordx4 v[84:87], v2, s[36:39], s73 offen nt
    s_waitcnt vmcnt(3)
    buffer_load_dwordx4 v[88:91], v2, s[36:39], s74 offen nt
    s_waitcnt vmcnt(3)
    buffer_load_dwordx4 v[92:95], v2, s[36:39], s75 offen nt
    v_mfma_f32_16x16x32_bf16 v[16:19], v[8:11], v[64:67], v[16:19]
    v_mov_b32_dpp v21, v20 row_newbcast:9 row_mask:0xf bank_mask:0xf
    v_perm_b32 v12, v21, v21, v4
    v_perm_b32 v13, v21, v21, v5
    v_perm_b32 v14, v21, v21, v6
    v_perm_b32 v15, v21, v21, v7
    s_nop 1
    v_mfma_f32_16x16x32_bf16 v[16:19], v[12:15], v[68:71], v[16:19]
    v_mov_b32_dpp v21, v20 row_newbcast:10 row_mask:0xf bank_mask:0xf
    v_perm_b32 v8, v21, v21, v4
    v_perm_b32 v9, v21, v21, v5
    v_perm_b32 v10, v21, v21, v6
    v_perm_b32 v11, v21, v21, v7
    s_nop 1
    v_mfma_f32_16x16x32_bf16 v[16:19], v[8:11], v[72:75], v[16:19]
    v_mov_b32_dpp v21, v20 row_newbcast:11 row_mask:0xf bank_mask:0xf
    v_perm_b32 v12, v21, v21, v4
    v_perm_b32 v13, v21, v21, v5
    v_perm_b32 v14, v21, v21, v6
    v_perm_b32 v15, v21, v21, v7
    s_nop 1
    v_mfma_f32_16x16x32_bf16 v[16:19], v[12:15], v[76:79], v[16:19]
    v_lshrrev_b32 v28, 1, v28
L_wait_f:
    ds_read_b32 v32, v28 offset:320
    ds_read_b32 v33, v165 offset:352
    s_waitcnt lgkmcnt(0)
    v_max_u32 v21, v32, v33
    v_cmp_eq_u32 vcc, -1, v21
    s_cbranch_vccnz L_wait_f_again
    v_readfirstlane_b32 s93, v33
    v_mul_f32 v24, v24, v32
    v_mul_f32 v16, v16, v32
    v_mul_f32 v17, v17, v32
    v_mul_f32 v18, v18, v32
    v_mul_f32 v19, v19, v32
    v_cvt_pk_bf16_f32 v26, v24, v24
    v_lshlrev_b32 v26, 16, v26
    v_sub_f32 v26, v24, v26
    v_cvt_pk_bf16_f32 v20, v24, v26
    s_cmp_ge_u32 s80, 64
    s_cbranch_scc1 L_pv_wo
    v_mov_b32_dpp v21, v20 row_newbcast:12 row_mask:0xf bank_mask:0xf
    v_perm_b32 v8, v21, v21, v4
    v_perm_b32 v9, v21, v21, v5
    v_perm_b32 v10, v21, v21, v6
    v_perm_b32 v11, v21, v21, v7
    s_waitcnt vmcnt(3)
    s_nop 0
    v_mfma_f32_16x16x32_bf16 v[16:19], v[8:11], v[80:83], v[16:19]
    s_mov_b64 exec, s[90:91]
    global_load_dword v3, v[162:163], off
    s_mov_b64 exec, -1
    s_mov_b32 s76, 0x4000
    s_mov_b32 s77, 0
    v_lshl_add_u64 v[162:163], v[162:163], 0, s[76:77]
    s_mov_b64 exec, s[90:91]
    global_load_dword v3, v[162:163], off
    s_mov_b64 exec, -1
    s_mov_b32 s76, 0xffffe000
    s_mov_b32 s77, -1
    v_lshl_add_u64 v[162:163], v[162:163], 0, s[76:77]
    v_mov_b32_dpp v21, v20 row_newbcast:13 row_mask:0xf bank_mask:0xf
    v_perm_b32 v12, v21, v21, v4
    v_perm_b32 v13, v21, v21, v5
    v_perm_b32 v14, v21, v21, v6
    v_perm_b32 v15, v21, v21, v7
    s_waitcnt vmcnt(4)
    s_nop 0
    v_mfma_f32_16x16x32_bf16 v[16:19], v[12:15], v[84:87], v[16:19]
    s_mov_b64 exec, s[90:91]
    global_load_dword v3, v[162:163], off
    s_mov_b64 exec, -1
    s_mov_b32 s76, 0x4000
    s_mov_b32 s77, 0
    v_lshl_add_u64 v[162:163], v[162:163], 0, s[76:77]
    v_mov_b32_dpp v21, v20 row_newbcast:14 row_mask:0xf bank_mask:0xf
    v_perm_b32 v8, v21, v21, v4
    v_perm_b32 v9, v21, v21, v5
    v_perm_b32 v10, v21, v21, v6
    v_perm_b32 v11, v21, v21, v7
    s_waitcnt vmcnt(4)
    s_nop 0
    v_mfma_f32_16x16x32_bf16 v[16:19], v[8:11], v[88:91], v[16:19]
    s_mov_b64 exec, s[90:91]
    global_load_dword v3, v[162:163], off
    s_mov_b64 exec, -1
    v_mov_b32_dpp v21, v20 row_newbcast:15 row_mask:0xf bank_mask:0xf
    v_perm_b32 v12, v21, v21, v4
    v_perm_b32 v13, v21, v21, v5
    v_perm_b32 v14, v21, v21, v6
    v_perm_b32 v15, v21, v21, v7
    s_waitcnt vmcnt(4)
    s_nop 0
    v_mfma_f32_16x16x32_bf16 v[16:19], v[12:15], v[92:95], v[16:19]
L_pv_done:
    s_cmp_lg_u32 s93, 0
    s_nop 6
    ds_write_b128 v147, v[16:19] offset:2048
    s_mov_b64 exec, 1
    ds_add_rtn_u32 v47, v165, v46 offset:356
    s_mov_b64 exec, -1
    ds_read_b128 v[36:39], v148 offset:2048
    ds_read_b128 v[64:67], v148 offset:3072
    ds_read_b128 v[68:71], v148 offset:4096
    ds_read_b128 v[72:75], v148 offset:5120
    ds_read_b128 v[96:99], v148 offset:6144
    ds_read_b128 v[100:103], v148 offset:7168
    ds_read_b128 v[104:107], v148 offset:8192
    ds_read_b128 v[108:111], v148 offset:9216
    s_waitcnt lgkmcnt(8)
    v_cmp_eq_u32 vcc, 6, v47
    s_cbranch_vccz L_published
    s_waitcnt lgkmcnt(6)
    v_pk_add_f32 v[36:37], v[36:37], v[64:65]
    v_pk_add_f32 v[38:39], v[38:39], v[66:67]
    s_waitcnt lgkmcnt(5)
    v_pk_add_f32 v[36:37], v[36:37], v[68:69]
    v_pk_add_f32 v[38:39], v[38:39], v[70:71]
    s_waitcnt lgkmcnt(4)
    v_pk_add_f32 v[36:37], v[36:37], v[72:73]
    v_pk_add_f32 v[38:39], v[38:39], v[74:75]
    s_waitcnt lgkmcnt(3)
    v_pk_add_f32 v[36:37], v[36:37], v[96:97]
    v_pk_add_f32 v[38:39], v[38:39], v[98:99]
    s_waitcnt lgkmcnt(2)
    v_pk_add_f32 v[36:37], v[36:37], v[100:101]
    v_pk_add_f32 v[38:39], v[38:39], v[102:103]
    s_waitcnt lgkmcnt(1)
    v_pk_add_f32 v[36:37], v[36:37], v[104:105]
    v_pk_add_f32 v[38:39], v[38:39], v[106:107]
    s_waitcnt lgkmcnt(0)
    v_pk_add_f32 v[36:37], v[36:37], v[108:109]
    v_pk_add_f32 v[38:39], v[38:39], v[110:111]
    s_nop 1
    v_permlane32_swap_b32 v36, v38
    v_permlane32_swap_b32 v37, v39
    v_pk_add_f32 v[36:37], v[36:37], v[38:39]
    v_bfi_b32 v37, v164, s92, v37
    s_cbranch_scc1 L_ost_through
    buffer_store_dwordx2 v[36:37], v149, s[48:51], s85 offen
L_ost_done:
L_published:
    s_waitcnt lgkmcnt(0)
    s_barrier
    s_cmp_ge_u32 s80, 64
    s_cbranch_scc1 L_wo
    s_cmp_lt_u32 s80, 43
    s_cbranch_scc1 L_ffn
    s_cmp_lg_u32 s5, 2
    s_cbranch_scc1 L_exit
    s_cmp_lt_u32 s89, 16
    s_cbranch_scc1 L_refresh
    global_load_dword v3, v[44:45], off
    s_mov_b32 s76, 0x2b00
    s_mov_b32 s77, 0
    v_lshl_add_u64 v[44:45], v[44:45], 0, s[76:77]
    global_load_dword v3, v[44:45], off
    s_mov_b32 s56, s24
    s_mov_b32 s57, s25
    s_mov_b32 s58, 1409024
    s_mov_b32 s59, 0x20000
    s_lshl_b32 s76, s94, 4
    s_and_b32 s78, s89, 15
    s_mul_i32 s78, s78, s76
    s_lshl_b32 s79, s88, 8
    s_add_u32 s78, s78, s79
    s_lshl_b32 s78, s78, 7
    v_lshlrev_b32 v32, 7, v1
    buffer_load_dword v3, v32, s[56:59], s78 offen
    s_sub_u32 s76, s76, 1
    v_add_u32 v32, 64, v1
    v_min_u32 v32, s76, v32
    v_lshlrev_b32 v32, 7, v32
    buffer_load_dword v3, v32, s[56:59], s78 offen
    s_mov_b32 s76, 0xa9500
    s_mov_b32 s77, 0
    v_lshl_add_u64 v[44:45], v[44:45], 0, s[76:77]
    global_load_dword v3, v[44:45], off
    s_mov_b32 s76, 0x2b00
    s_mov_b32 s77, 0
    v_lshl_add_u64 v[44:45], v[44:45], 0, s[76:77]
    global_load_dword v3, v[44:45], off
    s_branch L_exit
L_refresh:
    s_cmp_lt_u32 s89, 14
    s_cbranch_scc1 L_exit
    s_lshr_b32 s77, s84, 2
    s_and_b32 s76, s89, 1
    s_lshl1_add_u32 s76, s76, s77
    s_lshl_b32 s76, s76, 13
    s_add_u32 s76, s76, 131072
    v_lshlrev_b32 v32, 7, v1
L_refresh_loop:
    buffer_load_ubyte v24, v32, s[48:51], s76 offen offset:4 sc1
    s_sub_u32 s7, s7, 1
    s_cbranch_scc1 L_exit
    s_waitcnt vmcnt(0)
    v_cmp_ne_u32 vcc, s92, v24
    s_cbranch_vccnz L_refresh_loop
    s_branch L_exit
L_wait_q_again:
    s_sub_u32 s7, s7, 1
    s_cbranch_scc1 L_exit
    s_branch L_wait_q
L_wait_f_again:
    s_sub_u32 s7, s7, 1
    s_cbranch_scc1 L_exit
    s_branch L_wait_f
L_ost_through:
    buffer_store_dwordx2 v[36:37], v149, s[48:51], s85 offen sc1
    s_branch L_ost_done
L_helper:
    s_load_dword s6, s[30:31], 557060
    s_mov_b32 s7, 1048576
    s_lshl3_add_u32 s81, s3, s4
    s_getreg_b32 s84, hwreg(HW_REG_XCC_ID, 0, 3)
    v_and_b32 v1, 63, v0
    v_and_b32 v32, 8, v0
    v_mov_b32 v33, 0x0100
    v_mov_b32 v34, 0x0302
    v_cmp_ne_u32 vcc, 0, v32
    s_nop 1
    v_cndmask_b32 v33, v33, v34, vcc
    v_or_b32 v34, 0x0c0c0000, v33
    v_lshlrev_b32 v33, 16, v33
    v_or_b32 v33, 0x0c0c, v33
    v_and_b32 v32, 1, v0
    v_cmp_ne_u32 vcc, 0, v32
    s_nop 1
    v_cndmask_b32 v33, v34, v33, vcc
    v_bfe_u32 v32, v0, 1, 2
    v_mov_b32 v34, 0x0c0c0c0c
    v_cmp_eq_u32 vcc, 0, v32
    s_nop 1
    v_cndmask_b32 v4, v34, v33, vcc
    v_cmp_eq_u32 vcc, 1, v32
    s_nop 1
    v_cndmask_b32 v5, v34, v33, vcc
    v_cmp_eq_u32 vcc, 2, v32
    s_nop 1
    v_cndmask_b32 v6, v34, v33, vcc
    v_cmp_eq_u32 vcc, 3, v32
    s_nop 1
    v_cndmask_b32 v7, v34, v33, vcc
    s_mov_b32 s48, s30
    s_mov_b32 s49, s31
    s_mov_b32 s50, 2097152
    s_mov_b32 s51, 0x20000
    s_waitcnt vmcnt(16)
    v_and_b32 v33, 0xffff0000, v28
    v_lshlrev_b32 v32, 16, v28
    v_and_b32 v35, 0xffff0000, v29
    v_lshlrev_b32 v34, 16, v29
    v_and_b32 v37, 0xffff0000, v30
    v_lshlrev_b32 v36, 16, v30
    v_and_b32 v39, 0xffff0000, v31
    v_lshlrev_b32 v38, 16, v31
    v_add_f32 v40, v32, v33
    v_add_f32 v40, v40, v34
    v_add_f32 v40, v40, v35
    v_add_f32 v40, v40, v36
    v_add_f32 v40, v40, v37
    v_add_f32 v40, v40, v38
    v_add_f32 v40, v40, v39
    s_nop 1
    v_add_f32_dpp v40, v40, v40 quad_perm:[1,0,3,2] row_mask:0xf bank_mask:0xf
    s_nop 1
    v_add_f32_dpp v40, v40, v40 quad_perm:[2,3,0,1] row_mask:0xf bank_mask:0xf
    s_nop 1
    v_add_f32_dpp v40, v40, v40 row_half_mirror row_mask:0xf bank_mask:0xf
    s_nop 1
    v_add_f32_dpp v40, v40, v40 row_mirror row_mask:0xf bank_mask:0xf
    s_nop 1
    v_add_f32_dpp v40, v40, v40 row_bcast:15 row_mask:0xa bank_mask:0xf
    s_nop 1
    v_add_f32_dpp v40, v40, v40 row_bcast:31 row_mask:0xc bank_mask:0xf
    s_nop 0
    v_readlane_b32 s77, v40, 63
    v_mov_b32 v41, 0x3b000000
    s_nop 0
    v_mul_f32 v41, s77, v41
    v_sub_f32 v32, v32, v41
    v_sub_f32 v33, v33, v41
    v_sub_f32 v34, v34, v41
    v_sub_f32 v35, v35, v41
    v_sub_f32 v36, v36, v41
    v_sub_f32 v37, v37, v41
    v_sub_f32 v38, v38, v41
    v_sub_f32 v39, v39, v41
    v_mul_f32 v40, v32, v32
    v_fmac_f32 v40, v33, v33
    v_fmac_f32 v40, v34, v34
    v_fmac_f32 v40, v35, v35
    v_fmac_f32 v40, v36, v36
    v_fmac_f32 v40, v37, v37
    v_fmac_f32 v40, v38, v38
    v_fmac_f32 v40, v39, v39
    s_nop 1
    v_add_f32_dpp v40, v40, v40 quad_perm:[1,0,3,2] row_mask:0xf bank_mask:0xf
    s_nop 1
    v_add_f32_dpp v40, v40, v40 quad_perm:[2,3,0,1] row_mask:0xf bank_mask:0xf
    s_nop 1
    v_add_f32_dpp v40, v40, v40 row_half_mirror row_mask:0xf bank_mask:0xf
    s_nop 1
    v_add_f32_dpp v40, v40, v40 row_mirror row_mask:0xf bank_mask:0xf
    s_nop 1
    v_add_f32_dpp v40, v40, v40 row_bcast:15 row_mask:0xa bank_mask:0xf
    s_nop 1
    v_add_f32_dpp v40, v40, v40 row_bcast:31 row_mask:0xc bank_mask:0xf
    s_nop 0
    v_readlane_b32 s77, v40, 63
    v_mov_b32 v40, 0x3b000000
    s_nop 0
    v_mul_f32 v40, s77, v40
    v_cvt_pk_bf16_f32 v41, v41, v41
    v_lshlrev_b32 v41, 16, v41
    v_cvt_pk_bf16_f32 v40, v40, v40
    v_lshlrev_b32 v40, 16, v40
    v_add_f32 v40, 0x3727c5ac, v40
    v_cvt_pk_bf16_f32 v40, v40, v40
    v_lshlrev_b32 v40, 16, v40
    v_sqrt_f32 v40, v40
    s_nop 0
    v_cvt_pk_bf16_f32 v40, v40, v40
    v_lshlrev_b32 v40, 16, v40
    v_rcp_f32 v42, v40
    v_lshlrev_b32 v27, 16, v27
    v_sub_f32 v27, v27, v41
    v_cvt_pk_bf16_f32 v27, v27, v27
    v_lshlrev_b32 v27, 16, v27
    v_mul_f32 v27, v27, v42
    v_cvt_pk_bf16_f32 v20, v27, 0
    s_waitcnt lgkmcnt(0)
    s_add_u32 s92, s6, 1
    s_and_b32 s92, s92, 0xff
    s_mov_b32 s19, s92
    s_bfe_u32 s77, s6, 0x80008
    s_add_u32 s77, s77, 1
    s_cmp_lt_u32 s77, 255
    s_cselect_b32 s77, s77, 0
    s_lshl_b32 s77, s77, 8
    s_or_b32 s19, s19, s77
    s_bfe_u32 s77, s6, 0x80010
    s_add_u32 s77, s77, 1
    s_cmp_lt_u32 s77, 253
    s_cselect_b32 s77, s77, 0
    s_lshl_b32 s77, s77, 16
    s_or_b32 s19, s19, s77
    s_bfe_u32 s77, s6, 0x80018
    s_add_u32 s77, s77, 1
    s_cmp_lt_u32 s77, 251
    s_cselect_b32 s77, s77, 0
    s_lshl_b32 s77, s77, 24
    s_or_b32 s19, s19, s77
    s_and_b32 s6, s19, -8
    v_mov_b32_dpp v21, v20 row_newbcast:0 row_mask:0xf bank_mask:0xf
    v_perm_b32 v8, v21, v21, v4
    v_perm_b32 v9, v21, v21, v5
    v_perm_b32 v10, v21, v21, v6
    v_perm_b32 v11, v21, v21, v7
    s_waitcnt vmcnt(12)
    s_nop 0
    v_mfma_f32_16x16x32_bf16 v[16:19], v[8:11], v[48:51], 0
    v_mov_b32_dpp v21, v20 row_newbcast:1 row_mask:0xf bank_mask:0xf
    v_perm_b32 v12, v21, v21, v4
    v_perm_b32 v13, v21, v21, v5
    v_perm_b32 v14, v21, v21, v6
    v_perm_b32 v15, v21, v21, v7
    s_nop 1
    v_mfma_f32_16x16x32_bf16 v[16:19], v[12:15], v[52:55], v[16:19]
    v_mov_b32_dpp v21, v20 row_newbcast:2 row_mask:0xf bank_mask:0xf
    v_perm_b32 v8, v21, v21, v4
    v_perm_b32 v9, v21, v21, v5
    v_perm_b32 v10, v21, v21, v6
    v_perm_b32 v11, v21, v21, v7
    s_nop 1
    v_mfma_f32_16x16x32_bf16 v[16:19], v[8:11], v[56:59], v[16:19]
    v_mov_b32_dpp v21, v20 row_newbcast:3 row_mask:0xf bank_mask:0xf
    v_perm_b32 v12, v21, v21, v4
    v_perm_b32 v13, v21, v21, v5
    v_perm_b32 v14, v21, v21, v6
    v_perm_b32 v15, v21, v21, v7
    s_nop 1
    v_mfma_f32_16x16x32_bf16 v[16:19], v[12:15], v[60:63], v[16:19]
    v_mov_b32_dpp v21, v20 row_newbcast:4 row_mask:0xf bank_mask:0xf
    v_perm_b32 v8, v21, v21, v4
    v_perm_b32 v9, v21, v21, v5
    v_perm_b32 v10, v21, v21, v6
    v_perm_b32 v11, v21, v21, v7
    s_waitcnt vmcnt(8)
    s_nop 0
    v_mfma_f32_16x16x32_bf16 v[16:19], v[8:11], v[64:67], v[16:19]
    v_mov_b32_dpp v21, v20 row_newbcast:5 row_mask:0xf bank_mask:0xf
    v_perm_b32 v12, v21, v21, v4
    v_perm_b32 v13, v21, v21, v5
    v_perm_b32 v14, v21, v21, v6
    v_perm_b32 v15, v21, v21, v7
    s_nop 1
    v_mfma_f32_16x16x32_bf16 v[16:19], v[12:15], v[68:71], v[16:19]
    v_mov_b32_dpp v21, v20 row_newbcast:6 row_mask:0xf bank_mask:0xf
    v_perm_b32 v8, v21, v21, v4
    v_perm_b32 v9, v21, v21, v5
    v_perm_b32 v10, v21, v21, v6
    v_perm_b32 v11, v21, v21, v7
    s_nop 1
    v_mfma_f32_16x16x32_bf16 v[16:19], v[8:11], v[72:75], v[16:19]
    v_mov_b32_dpp v21, v20 row_newbcast:7 row_mask:0xf bank_mask:0xf
    v_perm_b32 v12, v21, v21, v4
    v_perm_b32 v13, v21, v21, v5
    v_perm_b32 v14, v21, v21, v6
    v_perm_b32 v15, v21, v21, v7
    s_nop 1
    v_mfma_f32_16x16x32_bf16 v[16:19], v[12:15], v[76:79], v[16:19]
    v_mov_b32_dpp v21, v20 row_newbcast:8 row_mask:0xf bank_mask:0xf
    v_perm_b32 v8, v21, v21, v4
    v_perm_b32 v9, v21, v21, v5
    v_perm_b32 v10, v21, v21, v6
    v_perm_b32 v11, v21, v21, v7
    s_waitcnt vmcnt(4)
    s_nop 0
    v_mfma_f32_16x16x32_bf16 v[16:19], v[8:11], v[80:83], v[16:19]
    v_mov_b32_dpp v21, v20 row_newbcast:9 row_mask:0xf bank_mask:0xf
    v_perm_b32 v12, v21, v21, v4
    v_perm_b32 v13, v21, v21, v5
    v_perm_b32 v14, v21, v21, v6
    v_perm_b32 v15, v21, v21, v7
    s_nop 1
    v_mfma_f32_16x16x32_bf16 v[16:19], v[12:15], v[84:87], v[16:19]
    v_mov_b32_dpp v21, v20 row_newbcast:10 row_mask:0xf bank_mask:0xf
    v_perm_b32 v8, v21, v21, v4
    v_perm_b32 v9, v21, v21, v5
    v_perm_b32 v10, v21, v21, v6
    v_perm_b32 v11, v21, v21, v7
    s_nop 1
    v_mfma_f32_16x16x32_bf16 v[16:19], v[8:11], v[88:91], v[16:19]
    v_mov_b32_dpp v21, v20 row_newbcast:11 row_mask:0xf bank_mask:0xf
    v_perm_b32 v12, v21, v21, v4
    v_perm_b32 v13, v21, v21, v5
    v_perm_b32 v14, v21, v21, v6
    v_perm_b32 v15, v21, v21, v7
    s_nop 1
    v_mfma_f32_16x16x32_bf16 v[16:19], v[12:15], v[92:95], v[16:19]
    v_mov_b32_dpp v21, v20 row_newbcast:12 row_mask:0xf bank_mask:0xf
    v_perm_b32 v8, v21, v21, v4
    v_perm_b32 v9, v21, v21, v5
    v_perm_b32 v10, v21, v21, v6
    v_perm_b32 v11, v21, v21, v7
    s_waitcnt vmcnt(0)
    s_nop 0
    v_mfma_f32_16x16x32_bf16 v[16:19], v[8:11], v[96:99], v[16:19]
    v_mov_b32_dpp v21, v20 row_newbcast:13 row_mask:0xf bank_mask:0xf
    v_perm_b32 v12, v21, v21, v4
    v_perm_b32 v13, v21, v21, v5
    v_perm_b32 v14, v21, v21, v6
    v_perm_b32 v15, v21, v21, v7
    s_nop 1
    v_mfma_f32_16x16x32_bf16 v[16:19], v[12:15], v[100:103], v[16:19]
    v_mov_b32_dpp v21, v20 row_newbcast:14 row_mask:0xf bank_mask:0xf
    v_perm_b32 v8, v21, v21, v4
    v_perm_b32 v9, v21, v21, v5
    v_perm_b32 v10, v21, v21, v6
    v_perm_b32 v11, v21, v21, v7
    s_nop 1
    v_mfma_f32_16x16x32_bf16 v[16:19], v[8:11], v[104:107], v[16:19]
    v_mov_b32_dpp v21, v20 row_newbcast:15 row_mask:0xf bank_mask:0xf
    v_perm_b32 v12, v21, v21, v4
    v_perm_b32 v13, v21, v21, v5
    v_perm_b32 v14, v21, v21, v6
    v_perm_b32 v15, v21, v21, v7
    s_nop 1
    v_mfma_f32_16x16x32_bf16 v[16:19], v[12:15], v[108:111], v[16:19]
    v_and_b32 v24, 15, v0
    v_bfe_u32 v25, v0, 4, 1
    v_lshrrev_b32 v26, 5, v0
    v_lshlrev_b32 v24, 6, v24
    v_lshl_add_u32 v24, v25, 5, v24
    v_lshl_add_u32 v24, v26, 4, v24
    s_lshl_b32 s78, s81, 10
    s_add_u32 s78, s78, 262144
    s_xor_b32 s79, s6, s84
    v_permlane32_swap_b32 v16, v18
    v_permlane32_swap_b32 v17, v19
    v_mov_b32 v18, v17
    v_mov_b32 v17, s6
    v_mov_b32 v19, s79
    buffer_store_dwordx4 v[16:19], v24, s[48:51], s78 offen
    s_lshl_b32 s76, s3, 13
    s_add_u32 s76, s76, 262144
    s_add_u32 s85, s76, 4096
    s_mov_b32 s77, 0
    s_waitcnt vmcnt(0)
    s_mov_b64 s[60:61], -1
    s_mov_b64 s[62:63], -1
    s_mov_b64 s[64:65], -1
    s_mov_b64 s[66:67], -1
    s_mov_b64 s[68:69], -1
    s_mov_b64 s[70:71], -1
    s_mov_b64 s[72:73], -1
    s_mov_b64 s[74:75], -1
L_gather_q:
    s_mov_b64 exec, s[60:61]
    buffer_load_dwordx4 v[48:51], v22, s[48:51], s76 offen offset:0 sc1
    s_mov_b64 exec, s[62:63]
    buffer_load_dwordx4 v[52:55], v22, s[48:51], s76 offen offset:1024 sc1
    s_mov_b64 exec, s[64:65]
    buffer_load_dwordx4 v[56:59], v22, s[48:51], s76 offen offset:2048 sc1
    s_mov_b64 exec, s[66:67]
    buffer_load_dwordx4 v[60:63], v22, s[48:51], s76 offen offset:3072 sc1
    s_mov_b64 exec, s[68:69]
    buffer_load_dwordx4 v[64:67], v22, s[48:51], s85 offen offset:0 sc1
    s_mov_b64 exec, s[70:71]
    buffer_load_dwordx4 v[68:71], v22, s[48:51], s85 offen offset:1024 sc1
    s_mov_b64 exec, s[72:73]
    buffer_load_dwordx4 v[72:75], v22, s[48:51], s85 offen offset:2048 sc1
    s_mov_b64 exec, s[74:75]
    buffer_load_dwordx4 v[76:79], v22, s[48:51], s85 offen offset:3072 sc1
    s_mov_b64 exec, -1
    s_sub_u32 s7, s7, 1
    s_cbranch_scc1 L_exit
    s_waitcnt vmcnt(0)
    s_mov_b64 s[82:83], 0
    v_xor_b32 v26, s6, v49
    v_xor_b32 v27, s6, v51
    v_or_b32 v26, v26, v27
    v_cmp_lt_u32 s[60:61], 7, v26
    s_or_b64 s[82:83], s[82:83], s[60:61]
    v_xor_b32 v26, s6, v53
    v_xor_b32 v27, s6, v55
    v_or_b32 v26, v26, v27
    v_cmp_lt_u32 s[62:63], 7, v26
    s_or_b64 s[82:83], s[82:83], s[62:63]
    v_xor_b32 v26, s6, v57
    v_xor_b32 v27, s6, v59
    v_or_b32 v26, v26, v27
    v_cmp_lt_u32 s[64:65], 7, v26
    s_or_b64 s[82:83], s[82:83], s[64:65]
    v_xor_b32 v26, s6, v61
    v_xor_b32 v27, s6, v63
    v_or_b32 v26, v26, v27
    v_cmp_lt_u32 s[66:67], 7, v26
    s_or_b64 s[82:83], s[82:83], s[66:67]
    v_xor_b32 v26, s6, v65
    v_xor_b32 v27, s6, v67
    v_or_b32 v26, v26, v27
    v_cmp_lt_u32 s[68:69], 7, v26
    s_or_b64 s[82:83], s[82:83], s[68:69]
    v_xor_b32 v26, s6, v69
    v_xor_b32 v27, s6, v71
    v_or_b32 v26, v26, v27
    v_cmp_lt_u32 s[70:71], 7, v26
    s_or_b64 s[82:83], s[82:83], s[70:71]
    v_xor_b32 v26, s6, v73
    v_xor_b32 v27, s6, v75
    v_or_b32 v26, v26, v27
    v_cmp_lt_u32 s[72:73], 7, v26
    s_or_b64 s[82:83], s[82:83], s[72:73]
    v_xor_b32 v26, s6, v77
    v_xor_b32 v27, s6, v79
    v_or_b32 v26, v26, v27
    v_cmp_lt_u32 s[74:75], 7, v26
    s_or_b64 s[82:83], s[82:83], s[74:75]
    s_cbranch_scc1 L_gather_q_again
    v_xor_b32 v51, s79, v51
    v_xor_b32 v55, s79, v55
    v_xor_b32 v59, s79, v59
    v_xor_b32 v63, s79, v63
    v_xor_b32 v67, s79, v67
    v_xor_b32 v71, s79, v71
    v_xor_b32 v75, s79, v75
    v_xor_b32 v79, s79, v79
    v_or3_b32 v26, v51, v55, v59
    v_or3_b32 v26, v26, v63, v67
    v_or3_b32 v26, v26, v71, v75
    v_or_b32 v26, v26, v79
    v_cmp_ne_u32 vcc, 0, v26
    s_cbranch_vccz L_same_die
    buffer_store_dwordx4 v[16:19], v24, s[48:51], s78 offen sc1
L_same_die:
    v_add_f32 v48, v48, v64
    v_add_f32 v50, v50, v66
    v_add_f32 v52, v52, v68
    v_add_f32 v54, v54, v70
    v_add_f32 v56, v56, v72
    v_add_f32 v58, v58, v74
    v_add_f32 v60, v60, v76
    v_add_f32 v62, v62, v78
    v_add_f32 v48, v48, v56
    v_add_f32 v50, v50, v58
    v_add_f32 v52, v52, v60
    v_add_f32 v54, v54, v62
    v_add_f32 v48, v48, v52
    v_add_f32 v50, v50, v54
    v_cvt_pk_bf16_f32 v48, v48, v50
    v_lshlrev_b32 v25, 2, v0
    v_min_u32 v48, -2, v48
    ds_write_b32 v25, v48 offset:0
    v_and_b32 v25, 3, v0
    v_lshlrev_b32 v41, 7, v25
    s_lshl_b32 s78, s81, 9
    buffer_load_dword v43, v41, s[48:51], s78 offen sc1
    v_bfe_u32 v26, v0, 2, 1
    v_lshlrev_b32 v25, 16, v25
    v_lshl_add_u32 v25, v26, 10, v25
    s_and_b32 s76, s3, 7
    s_lshl_b32 s77, s76, 13
    s_add_u32 s77, s77, 262144
    buffer_load_dword v40, v25, s[48:51], s77 offen offset:12 sc1
    v_and_b32 v28, 7, v0
    v_lshlrev_b32 v29, 2, v28
    v_lshlrev_b32 v28, 3, v28
L_wait_stats:
    ds_read_b64 v[26:27], v28 offset:256
    s_waitcnt lgkmcnt(0)
    v_max_u32 v21, v26, v27
    v_cmp_eq_u32 vcc, -1, v21
    s_cbranch_vccnz L_wait_stats_again
    v_mov_b32 v30, v26
    s_nop 1
    v_max_f32_dpp v30, v30, v30 quad_perm:[1,0,3,2] row_mask:0xf bank_mask:0xf
    s_nop 1
    v_max_f32_dpp v30, v30, v30 quad_perm:[2,3,0,1] row_mask:0xf bank_mask:0xf
    s_nop 1
    v_max_f32_dpp v30, v30, v30 row_half_mirror row_mask:0xf bank_mask:0xf
    v_sub_f32 v26, v26, v30
    v_mul_f32 v26, 0x3fb8aa3b, v26
    v_exp_f32 v26, v26
    s_nop 0
    ds_write_b32 v29, v26 offset:320
    v_mov_b32 v36, v30
    v_mov_b32 v37, s6
    v_mul_f32 v38, v26, v27
    v_mov_b32 v39, s6
    s_nop 0
    v_add_f32_dpp v38, v38, v38 quad_perm:[1,0,3,2] row_mask:0xf bank_mask:0xf
    s_nop 1
    v_add_f32_dpp v38, v38, v38 quad_perm:[2,3,0,1] row_mask:0xf bank_mask:0xf
    s_nop 1
    v_add_f32_dpp v38, v38, v38 row_half_mirror row_mask:0xf bank_mask:0xf
    s_lshl_b32 s77, s81, 7
    s_add_u32 s77, s77, 524288
    s_waitcnt vmcnt(0)
    v_cmp_ne_u32 vcc, s79, v40
    s_cmp_lg_u64 vcc, 0
    s_cselect_b32 s93, 1, 0
    v_mov_b32 v40, s93
    v_mov_b32 v41, 0
    s_mov_b64 exec, 1
    ds_write_b32 v41, v40 offset:352
    s_cbranch_scc1 L_mst_through
    buffer_store_dwordx4 v[36:39], off, s[48:51], s77
L_mst_done:
    s_mov_b64 exec, -1
    s_waitcnt lgkmcnt(0)
    s_cmp_ge_u32 s4, 2
    s_cbranch_scc1 L_exit
    v_bfe_u32 v24, v0, 3, 2
    v_and_b32 v25, 7, v0
    v_lshlrev_b32 v24, 13, v24
    v_lshl_add_u32 v24, v25, 7, v24
    s_lshl_b32 s76, s76, 10
    s_add_u32 s76, s76, 524288
    s_waitcnt vmcnt(0)
    s_mov_b64 s[60:61], -1
L_gather_m:
    s_mov_b64 exec, s[60:61]
    buffer_load_dwordx4 v[32:35], v24, s[48:51], s76 offen sc1
    s_mov_b64 exec, -1
    s_sub_u32 s7, s7, 1
    s_cbranch_scc1 L_exit
    s_waitcnt vmcnt(0)
    s_mov_b64 s[82:83], 0
    v_xor_b32 v26, s6, v33
    v_xor_b32 v27, s6, v35
    v_or_b32 v26, v26, v27
    v_cmp_lt_u32 s[60:61], 0, v26
    s_or_b64 s[82:83], s[82:83], s[60:61]
    s_cbranch_scc1 L_gather_m
    v_mov_b32 v36, v32
    s_nop 1
    v_max_f32_dpp v36, v36, v36 quad_perm:[1,0,3,2] row_mask:0xf bank_mask:0xf
    s_nop 1
    v_max_f32_dpp v36, v36, v36 quad_perm:[2,3,0,1] row_mask:0xf bank_mask:0xf
    s_nop 1
    v_max_f32_dpp v36, v36, v36 row_half_mirror row_mask:0xf bank_mask:0xf
    v_sub_f32 v32, v32, v36
    v_mul_f32 v32, 0x3fb8aa3b, v32
    v_exp_f32 v32, v32
    s_nop 0
    v_mul_f32 v34, v32, v34
    s_nop 1
    v_add_f32_dpp v34, v34, v34 quad_perm:[1,0,3,2] row_mask:0xf bank_mask:0xf
    s_nop 1
    v_add_f32_dpp v34, v34, v34 quad_perm:[2,3,0,1] row_mask:0xf bank_mask:0xf
    s_nop 1
    v_add_f32_dpp v34, v34, v34 row_half_mirror row_mask:0xf bank_mask:0xf
    v_rcp_f32 v34, v34
    v_and_b32 v24, 31, v0
    v_lshlrev_b32 v24, 2, v24
    v_mul_f32 v32, v32, v34
    ds_write_b32 v24, v32 offset:384
    s_waitcnt lgkmcnt(0)
    s_branch L_exit
L_gather_q_again:
    s_add_u32 s77, s77, 1
    s_cmp_lg_u32 s77, 4
    s_cbranch_scc1 L_gather_q
    buffer_store_dwordx4 v[16:19], v24, s[48:51], s78 offen sc1
    s_branch L_gather_q
L_wait_stats_again:
    s_sleep 2
    s_sub_u32 s7, s7, 1
    s_cbranch_scc1 L_exit
    s_branch L_wait_stats
L_mst_through:
    buffer_store_dwordx4 v[36:39], off, s[48:51], s77 sc1
    s_branch L_mst_done
L_pv_wo:
    s_lshr_b32 s77, s5, 1
    s_lshl_b32 s76, s77, 5
    v_lshl_add_u32 v119, v146, 4, s76
    s_and_b32 s78, s3, 7
    s_lshl3_add_u32 s79, s77, s78
    s_lshl_b32 s79, s79, 12
    s_and_b32 s77, s5, 1
    s_lshl_b32 s77, s77, 8
    s_add_u32 s60, s77, s79
    v_lshlrev_b32 v116, 11, v146
    v_lshl_add_u32 v116, v151, 3, v116
    v_and_b32 v117, 0xf0, v149
    v_lshrrev_b32 v32, 5, v0
    v_lshl_add_u32 v117, v32, 9, v117
    v_and_b32 v32, 1, v32
    v_and_b32 v33, 31, v0
    v_lshlrev_b32 v33, 3, v33
    v_lshl_add_u32 v118, v32, 13, v33
    v_lshl_add_u32 v120, v32, 12, v33
    v_add_u32 v120, 10240, v120
    s_and_b32 s79, s78, 4
    s_add_u32 s78, s78, s79
    s_lshl_b32 s78, s78, 11
    s_and_b32 s79, s80, 7
    s_lshl_b32 s79, s79, 8
    s_add_u32 s78, s78, s79
    s_add_u32 s61, s78, 131072
    s_mov_b32 s62, 0x00ff00ff
    s_mov_b32 s63, 0xff00ff00
    v_mov_b32_dpp v21, v20 row_newbcast:12 row_mask:0xf bank_mask:0xf
    v_perm_b32 v8, v21, v21, v4
    v_perm_b32 v9, v21, v21, v5
    v_perm_b32 v10, v21, v21, v6
    v_perm_b32 v11, v21, v21, v7
    s_waitcnt vmcnt(3)
    s_nop 0
    v_mfma_f32_16x16x32_bf16 v[16:19], v[8:11], v[80:83], v[16:19]
    v_mov_b32_dpp v21, v20 row_newbcast:13 row_mask:0xf bank_mask:0xf
    v_perm_b32 v12, v21, v21, v4
    v_perm_b32 v13, v21, v21, v5
    v_perm_b32 v14, v21, v21, v6
    v_perm_b32 v15, v21, v21, v7
    s_waitcnt vmcnt(2)
    s_nop 0
    v_mfma_f32_16x16x32_bf16 v[16:19], v[12:15], v[84:87], v[16:19]
    v_mov_b32_dpp v21, v20 row_newbcast:14 row_mask:0xf bank_mask:0xf
    v_perm_b32 v8, v21, v21, v4
    v_perm_b32 v9, v21, v21, v5
    v_perm_b32 v10, v21, v21, v6
    v_perm_b32 v11, v21, v21, v7
    s_waitcnt vmcnt(1)
    s_nop 0
    v_mfma_f32_16x16x32_bf16 v[16:19], v[8:11], v[88:91], v[16:19]
    global_load_dwordx4 v[48:51], v[44:45], off nt
    v_lshl_add_u64 v[44:45], v[44:45], 0, s[82:83]
    v_mov_b32_dpp v21, v20 row_newbcast:15 row_mask:0xf bank_mask:0xf
    v_perm_b32 v12, v21, v21, v4
    v_perm_b32 v13, v21, v21, v5
    v_perm_b32 v14, v21, v21, v6
    v_perm_b32 v15, v21, v21, v7
    s_waitcnt vmcnt(1)
    s_nop 0
    v_mfma_f32_16x16x32_bf16 v[16:19], v[12:15], v[92:95], v[16:19]
    global_load_dwordx4 v[52:55], v[44:45], off nt
    v_lshl_add_u64 v[44:45], v[44:45], 0, s[82:83]
    global_load_dwordx4 v[56:59], v[44:45], off nt
    v_lshl_add_u64 v[44:45], v[44:45], 0, s[82:83]
    global_load_dwordx4 v[60:63], v[44:45], off nt
    v_lshl_add_u64 v[44:45], v[44:45], 0, s[82:83]
    s_branch L_pv_done
L_wo:
    ds_read_b128 v[112:115], v119 offset:384
    global_load_dwordx4 v[128:131], v[44:45], off nt
    v_lshl_add_u64 v[44:45], v[44:45], 0, s[82:83]
    global_load_dwordx4 v[132:135], v[44:45], off nt
    v_lshl_add_u64 v[44:45], v[44:45], 0, s[82:83]
    global_load_dwordx4 v[136:139], v[44:45], off nt
    v_lshl_add_u64 v[44:45], v[44:45], 0, s[82:83]
    global_load_dwordx4 v[140:143], v[44:45], off nt
    s_waitcnt lgkmcnt(0)
L_poll_o:
    buffer_load_dwordx2 v[32:33], v116, s[48:51], s60 offen offset:0 sc1
    buffer_load_dwordx2 v[34:35], v116, s[48:51], s60 offen offset:512 sc1
    buffer_load_dwordx2 v[36:37], v116, s[48:51], s60 offen offset:1024 sc1
    buffer_load_dwordx2 v[38:39], v116, s[48:51], s60 offen offset:1536 sc1
    s_sub_u32 s7, s7, 1
    s_cbranch_scc1 L_exit
    s_waitcnt vmcnt(0)
    v_xor_b32 v33, s92, v33
    v_xor_b32 v35, s92, v35
    v_xor_b32 v37, s92, v37
    v_xor_b32 v39, s92, v39
    v_or3_b32 v3, v33, v35, v37
    v_or_b32 v3, v3, v39
    v_cmp_ne_u32_sdwa vcc, v3, v165 src0_sel:BYTE_0 src1_sel:DWORD
    v_pk_mul_f32 v[32:33], v[32:33], v[112:113] op_sel_hi:[1,0]
    v_pk_fma_f32 v[32:33], v[34:35], v[112:113], v[32:33] op_sel:[0,1,0]
    v_pk_fma_f32 v[32:33], v[36:37], v[114:115], v[32:33] op_sel_hi:[1,0,1]
    v_pk_fma_f32 v[32:33], v[38:39], v[114:115], v[32:33] op_sel:[0,1,0]
    s_cbranch_vccnz L_poll_o
    s_nop 0
    v_add_f32_dpp v32, v32, v32 row_ror:8 row_mask:0xf bank_mask:0xf
    v_add_f32_dpp v33, v33, v33 row_ror:8 row_mask:0xf bank_mask:0xf
    v_cvt_pk_bf16_f32 v20, v32, v33
    s_nop 1
    v_mov_b32_dpp v21, v20 row_newbcast:0 row_mask:0xf bank_mask:0xf
    v_perm_b32 v8, v21, v21, v4
    v_perm_b32 v9, v21, v21, v5
    v_perm_b32 v10, v21, v21, v6
    v_perm_b32 v11, v21, v21, v7
    v_mov_b32_dpp v21, v20 row_newbcast:1 row_mask:0xf bank_mask:0xf
    v_perm_b32 v12, v21, v21, v4
    v_perm_b32 v13, v21, v21, v5
    v_perm_b32 v14, v21, v21, v6
    v_perm_b32 v15, v21, v21, v7
    v_mfma_f32_16x16x32_bf16 v[16:19], v[8:11], v[48:51], 0
    v_mov_b32_dpp v21, v20 row_newbcast:2 row_mask:0xf bank_mask:0xf
    v_perm_b32 v8, v21, v21, v4
    v_perm_b32 v9, v21, v21, v5
    v_perm_b32 v10, v21, v21, v6
    v_perm_b32 v11, v21, v21, v7
    v_mfma_f32_16x16x32_bf16 v[16:19], v[12:15], v[52:55], v[16:19]
    v_mov_b32_dpp v21, v20 row_newbcast:3 row_mask:0xf bank_mask:0xf
    v_perm_b32 v12, v21, v21, v4
    v_perm_b32 v13, v21, v21, v5
    v_perm_b32 v14, v21, v21, v6
    v_perm_b32 v15, v21, v21, v7
    v_mfma_f32_16x16x32_bf16 v[16:19], v[8:11], v[56:59], v[16:19]
    v_mov_b32_dpp v21, v20 row_newbcast:4 row_mask:0xf bank_mask:0xf
    v_perm_b32 v8, v21, v21, v4
    v_perm_b32 v9, v21, v21, v5
    v_perm_b32 v10, v21, v21, v6
    v_perm_b32 v11, v21, v21, v7
    v_mfma_f32_16x16x32_bf16 v[16:19], v[12:15], v[60:63], v[16:19]
    v_mov_b32_dpp v21, v20 row_newbcast:5 row_mask:0xf bank_mask:0xf
    v_perm_b32 v12, v21, v21, v4
    v_perm_b32 v13, v21, v21, v5
    v_perm_b32 v14, v21, v21, v6
    v_perm_b32 v15, v21, v21, v7
    v_mfma_f32_16x16x32_bf16 v[16:19], v[8:11], v[128:131], v[16:19]
    v_mov_b32_dpp v21, v20 row_newbcast:6 row_mask:0xf bank_mask:0xf
    v_perm_b32 v8, v21, v21, v4
    v_perm_b32 v9, v21, v21, v5
    v_perm_b32 v10, v21, v21, v6
    v_perm_b32 v11, v21, v21, v7
    v_mfma_f32_16x16x32_bf16 v[16:19], v[12:15], v[132:135], v[16:19]
    v_mov_b32_dpp v21, v20 row_newbcast:7 row_mask:0xf bank_mask:0xf
    v_perm_b32 v12, v21, v21, v4
    v_perm_b32 v13, v21, v21, v5
    v_perm_b32 v14, v21, v21, v6
    v_perm_b32 v15, v21, v21, v7
    v_mfma_f32_16x16x32_bf16 v[16:19], v[8:11], v[136:139], v[16:19]
    s_nop 0
    v_mfma_f32_16x16x32_bf16 v[16:19], v[12:15], v[140:143], v[16:19]
    s_mov_b64 exec, s[62:63]
    s_nop 6
    ds_write_b128 v117, v[16:19] offset:10240
    s_mov_b64 exec, 1
    ds_add_rtn_u32 v47, v165, v46 offset:360
    s_mov_b64 exec, -1
    ds_read2st64_b64 v[24:27], v120 offset0:0 offset1:1
    ds_read2st64_b64 v[28:31], v120 offset0:2 offset1:3
    ds_read2st64_b64 v[32:35], v120 offset0:4 offset1:5
    ds_read2st64_b64 v[36:39], v120 offset0:6 offset1:7
    s_waitcnt lgkmcnt(4)
    v_cmp_eq_u32 vcc, 6, v47
    s_cbranch_vccz L_exit
    s_waitcnt lgkmcnt(2)
    v_pk_add_f32 v[24:25], v[24:25], v[26:27]
    v_pk_add_f32 v[28:29], v[28:29], v[30:31]
    v_pk_add_f32 v[24:25], v[24:25], v[28:29]
    s_waitcnt lgkmcnt(0)
    v_pk_add_f32 v[32:33], v[32:33], v[34:35]
    v_pk_add_f32 v[36:37], v[36:37], v[38:39]
    v_pk_add_f32 v[32:33], v[32:33], v[36:37]
    v_pk_add_f32 v[26:27], v[24:25], v[32:33]
    v_pk_add_f32 v[24:25], v[24:25], v[32:33]
    s_nop 1
    v_permlane32_swap_b32 v24, v26
    v_permlane32_swap_b32 v25, v27
    v_pk_add_f32 v[24:25], v[24:25], v[26:27]
    v_bfi_b32 v25, v164, s92, v25
    buffer_store_dwordx2 v[24:25], v118, s[48:51], s61 offen sc1
    s_branch L_exit
L_ffn:
    global_load_dwordx4 v[48:51], v[44:45], off
    v_lshl_add_u64 v[44:45], v[44:45], 0, s[82:83]
    global_load_dwordx4 v[52:55], v[44:45], off
    v_lshl_add_u64 v[44:45], v[44:45], 0, s[82:83]
    global_load_dwordx4 v[56:59], v[44:45], off
    v_lshl_add_u64 v[44:45], v[44:45], 0, s[82:83]
    global_load_dwordx4 v[60:63], v[44:45], off
    v_lshl_add_u64 v[44:45], v[44:45], 0, s[82:83]
    global_load_dwordx4 v[64:67], v[44:45], off
    v_lshl_add_u64 v[44:45], v[44:45], 0, s[82:83]
    global_load_dwordx4 v[68:71], v[44:45], off
    v_lshl_add_u64 v[44:45], v[44:45], 0, s[82:83]
    global_load_dwordx4 v[72:75], v[44:45], off
    v_lshl_add_u64 v[44:45], v[44:45], 0, s[82:83]
    global_load_dwordx4 v[76:79], v[44:45], off
    s_lshl_b32 s77, s5, 7
    v_lshlrev_b32 v157, 2, v151
    buffer_load_dword v152, v157, s[44:47], s77 offen
    v_add_u32 v157, s77, v157
    s_cmp_ge_u32 s5, 4
    s_cbranch_scc1 L_no_down
    s_mov_b32 s56, s24
    s_mov_b32 s57, s25
    s_mov_b32 s58, 1409024
    s_mov_b32 s59, 0x20000
    v_lshl_add_u32 v23, v144, 11, v22
    s_lshl_b32 s79, s80, 15
    s_lshl_b32 s78, s5, 8
    s_add_u32 s79, s79, s78
    buffer_load_dwordx4 v[80:83], v23, s[56:59], s79 offen offset:0 nt
    buffer_load_dwordx4 v[96:99], v23, s[56:59], s79 offen offset:1024 nt
    s_add_u32 s79, s79, 8192
    buffer_load_dwordx4 v[84:87], v23, s[56:59], s79 offen offset:0 nt
    buffer_load_dwordx4 v[100:103], v23, s[56:59], s79 offen offset:1024 nt
    s_add_u32 s79, s79, 8192
    buffer_load_dwordx4 v[88:91], v23, s[56:59], s79 offen offset:0 nt
    buffer_load_dwordx4 v[104:107], v23, s[56:59], s79 offen offset:1024 nt
    s_add_u32 s79, s79, 8192
    buffer_load_dwordx4 v[92:95], v23, s[56:59], s79 offen offset:0 nt
    buffer_load_dwordx4 v[108:111], v23, s[56:59], s79 offen offset:1024 nt
L_no_down:
    v_lshlrev_b32 v153, 3, v151
    v_lshl_add_u32 v153, v146, 14, v153
    s_lshl_b32 s76, s5, 8
    s_add_u32 s76, s76, 131072
    s_lshr_b32 s77, s84, 2
    s_lshl_b32 s77, s77, 13
    s_add_u32 s76, s76, s77
    s_add_u32 s77, s76, 4096
    s_mul_i32 s78, s5, 1216
    s_add_u32 s78, s78, 10240
    v_mul_u32_u24 v161, 608, v146
    v_add_u32 v161, s78, v161
    v_bfe_u32 v30, v0, 1, 1
    v_lshl_add_u32 v161, v30, 4, v161
    v_bfe_u32 v30, v0, 2, 1
    v_lshl_add_u32 v161, v30, 3, v161
    v_and_b32 v30, 1, v0
    v_lshl_add_u32 v161, v30, 2, v161
    v_and_b32 v30, 1, v144
    v_mul_u32_u24 v30, 320, v30
    v_add_u32 v161, v30, v161
    v_bfe_u32 v30, v0, 2, 2
    v_mul_u32_u24 v154, 2432, v30
    v_lshl_add_u32 v154, v144, 6, v154
    v_and_b32 v31, 3, v0
    v_lshl_add_u32 v154, v31, 4, v154
    v_mul_u32_u24 v156, 38, v22
    v_add_u32 v156, 10240, v156
    v_lshlrev_b32 v155, 1, v22
    v_lshl_add_u32 v155, v144, 3, v155
    s_and_b32 s78, s80, -4
    s_add_u32 s78, s78, s80
    s_lshl_b32 s78, s78, 11
    s_lshl_b32 s79, s5, 9
    s_add_u32 s78, s78, s79
    s_add_u32 s78, s78, 655360
    s_lshl1_add_u32 s68, s80, s5
    s_cmp_lt_u32 s5, 2
    s_cselect_b32 s68, s68, 32
    s_min_u32 s68, s68, 32
    v_lshrrev_b32 v158, 2, v1
    v_lshl_add_u32 v158, v144, 2, v158
    v_lshlrev_b32 v158, 11, v158
    v_lshl_add_u32 v158, v31, 4, v158
    v_lshl_add_u32 v159, v31, 2, v144
    s_lshl_b32 s79, s68, 4
    v_add_lshl_u32 v159, s79, v159, 1
    s_lshl_b32 s60, s68, 6
    s_add_u32 s60, s60, 655360
    s_add_u32 s61, s60, 0x10000
    s_add_u32 s62, s60, 0x20000
    s_mov_b32 s52, s26
    s_mov_b32 s53, s27
    s_mov_b32 s54, 1024
    s_mov_b32 s55, 0x20000
    s_mov_b32 s64, 0x05040100
    s_mov_b32 s65, 0x07060302
    s_mov_b32 s66, 0xbfb8aa3b
    s_mov_b32 s67, 0xbfb8aa3b
    s_mov_b32 s82, 0xffff00ff
    s_mov_b32 s83, 0x0000ff00
    v_mov_b32 v8, 0x3f803f80
    v_mov_b32 v9, 0x3f803f80
    v_mov_b32 v10, 0x3f803f80
    v_mov_b32 v11, 0x3f803f80
    v_mov_b32 v24, 0
    v_mov_b32 v25, 0
    v_mov_b32 v26, 0
    v_mov_b32 v27, 0
    v_mov_b32 v28, 0
    v_mov_b32 v29, 0
    v_mov_b32 v30, 0
    v_mov_b32 v31, 0
    v_mov_b32 v32, 0
    v_mov_b32 v33, 0
    v_mov_b32 v34, 0
    v_mov_b32 v35, 0
    v_mov_b32 v36, 0
    v_mov_b32 v37, 0
    v_mov_b32 v38, 0
    v_mov_b32 v39, 0
    s_cmp_ge_u32 s5, 4
    s_cbranch_scc1 L_tr_all
    s_waitcnt vmcnt(8)
    s_branch L_tr_gu
L_tr_all:
    s_waitcnt vmcnt(0)
L_tr_gu:
    v_perm_b32 v112, v52, v48, s64
    v_perm_b32 v116, v52, v48, s65
    v_perm_b32 v113, v60, v56, s64
    v_perm_b32 v117, v60, v56, s65
    v_perm_b32 v114, v68, v64, s64
    v_perm_b32 v118, v68, v64, s65
    v_perm_b32 v115, v76, v72, s64
    v_perm_b32 v119, v76, v72, s65
    v_perm_b32 v120, v53, v49, s64
    v_perm_b32 v124, v53, v49, s65
    v_perm_b32 v121, v61, v57, s64
    v_perm_b32 v125, v61, v57, s65
    v_perm_b32 v122, v69, v65, s64
    v_perm_b32 v126, v69, v65, s65
    v_perm_b32 v123, v77, v73, s64
    v_perm_b32 v127, v77, v73, s65
    v_perm_b32 v128, v54, v50, s64
    v_perm_b32 v132, v54, v50, s65
    v_perm_b32 v129, v62, v58, s64
    v_perm_b32 v133, v62, v58, s65
    v_perm_b32 v130, v70, v66, s64
    v_perm_b32 v134, v70, v66, s65
    v_perm_b32 v131, v78, v74, s64
    v_perm_b32 v135, v78, v74, s65
    v_perm_b32 v136, v55, v51, s64
    v_perm_b32 v140, v55, v51, s65
    v_perm_b32 v137, v63, v59, s64
    v_perm_b32 v141, v63, v59, s65
    v_perm_b32 v138, v71, v67, s64
    v_perm_b32 v142, v71, v67, s65
    v_perm_b32 v139, v79, v75, s64
    v_perm_b32 v143, v79, v75, s65
    v_and_b32 v13, 0xffff0000, v152
    v_lshlrev_b32 v12, 16, v152
    s_cbranch_scc1 L_tr_done
    s_waitcnt vmcnt(0)
    v_perm_b32 v48, v84, v80, s64
    v_perm_b32 v52, v84, v80, s65
    v_perm_b32 v49, v92, v88, s64
    v_perm_b32 v53, v92, v88, s65
    v_perm_b32 v50, v100, v96, s64
    v_perm_b32 v54, v100, v96, s65
    v_perm_b32 v51, v108, v104, s64
    v_perm_b32 v55, v108, v104, s65
    v_perm_b32 v56, v85, v81, s64
    v_perm_b32 v60, v85, v81, s65
    v_perm_b32 v57, v93, v89, s64
    v_perm_b32 v61, v93, v89, s65
    v_perm_b32 v58, v101, v97, s64
    v_perm_b32 v62, v101, v97, s65
    v_perm_b32 v59, v109, v105, s64
    v_perm_b32 v63, v109, v105, s65
    v_perm_b32 v64, v86, v82, s64
    v_perm_b32 v68, v86, v82, s65
    v_perm_b32 v65, v94, v90, s64
    v_perm_b32 v69, v94, v90, s65
    v_perm_b32 v66, v102, v98, s64
    v_perm_b32 v70, v102, v98, s65
    v_perm_b32 v67, v110, v106, s64
    v_perm_b32 v71, v110, v106, s65
    v_perm_b32 v72, v87, v83, s64
    v_perm_b32 v76, v87, v83, s65
    v_perm_b32 v73, v95, v91, s64
    v_perm_b32 v77, v95, v91, s65
    v_perm_b32 v74, v103, v99, s64
    v_perm_b32 v78, v103, v99, s65
    v_perm_b32 v75, v111, v107, s64
    v_perm_b32 v79, v111, v107, s65
L_tr_done:
L_poll_y:
    buffer_load_dwordx2 v[40:41], v153, s[48:51], s76 offen offset:0 sc1
    buffer_load_dwordx2 v[42:43], v153, s[48:51], s76 offen offset:2048 sc1
    buffer_load_dwordx2 v[44:45], v153, s[48:51], s77 offen offset:0 sc1
    buffer_load_dwordx2 v[46:47], v153, s[48:51], s77 offen offset:2048 sc1
    s_sub_u32 s7, s7, 1
    s_cbranch_scc1 L_exit
    s_waitcnt vmcnt(0)
    v_xor_b32 v41, s92, v41
    v_xor_b32 v43, s92, v43
    v_xor_b32 v45, s92, v45
    v_xor_b32 v47, s92, v47
    v_or3_b32 v3, v41, v43, v45
    v_or_b32 v3, v3, v47
    v_cmp_ne_u32_sdwa vcc, v3, v165 src0_sel:BYTE_0 src1_sel:DWORD
    v_pk_add_f32 v[40:41], v[40:41], v[42:43]
    v_pk_add_f32 v[44:45], v[44:45], v[46:47]
    v_pk_add_f32 v[14:15], v[40:41], v[44:45]
    s_cbranch_vccnz L_poll_y
    s_cmp_ge_u32 s5, 4
    v_add_f32_dpp v14, v14, v14 row_ror:8 row_mask:0xf bank_mask:0xf
    v_add_f32_dpp v15, v15, v15 row_ror:8 row_mask:0xf bank_mask:0xf
    v_cvt_pk_bf16_f32 v14, v14, v15
    v_and_b32 v15, 0xffff0000, v14
    v_lshlrev_b32 v14, 16, v14
    v_pk_add_f32 v[14:15], v[14:15], v[12:13]
    v_cvt_pk_bf16_f32 v20, v14, v15
    ds_write_b32 v157, v20 offset:512
    s_nop 0
    v_mov_b32_dpp v8, v20 row_newbcast:0 row_mask:0xf bank_mask:0x1
    v_mov_b32_dpp v9, v20 row_newbcast:1 row_mask:0xf bank_mask:0x1
    v_mov_b32_dpp v10, v20 row_newbcast:2 row_mask:0xf bank_mask:0x1
    v_mov_b32_dpp v11, v20 row_newbcast:3 row_mask:0xf bank_mask:0x1
    v_mov_b32_dpp v8, v20 row_newbcast:4 row_mask:0xf bank_mask:0x4
    v_mov_b32_dpp v9, v20 row_newbcast:5 row_mask:0xf bank_mask:0x4
    v_mov_b32_dpp v10, v20 row_newbcast:6 row_mask:0xf bank_mask:0x4
    v_mov_b32_dpp v11, v20 row_newbcast:7 row_mask:0xf bank_mask:0x4
    s_nop 1
    v_mfma_f32_16x16x32_bf16 v[16:19], v[8:11], v[8:11], 0
    v_mfma_f32_16x16x32_bf16 v[80:83], v[8:11], v[112:115], 0
    v_mfma_f32_16x16x32_bf16 v[84:87], v[8:11], v[116:119], 0
    v_mfma_f32_16x16x32_bf16 v[88:91], v[8:11], v[120:123], 0
    v_mfma_f32_16x16x32_bf16 v[92:95], v[8:11], v[124:127], 0
    v_mfma_f32_16x16x32_bf16 v[96:99], v[8:11], v[128:131], 0
    v_mfma_f32_16x16x32_bf16 v[100:103], v[8:11], v[132:135], 0
    v_mfma_f32_16x16x32_bf16 v[104:107], v[8:11], v[136:139], 0
    v_mfma_f32_16x16x32_bf16 v[108:111], v[8:11], v[140:143], 0
    s_mov_b64 exec, s[82:83]
    ds_write_b32 v161, v16 offset:256
    ds_write2_b32 v161, v80, v84 offset0:0 offset1:8
    s_nop 0
    ds_write2_b32 v161, v88, v92 offset0:16 offset1:24
    s_nop 0
    ds_write2_b32 v161, v96, v100 offset0:32 offset1:40
    s_nop 0
    ds_write2_b32 v161, v104, v108 offset0:48 offset1:56
    s_mov_b64 exec, -1
    s_waitcnt lgkmcnt(0)
    s_barrier
    s_cbranch_scc1 L_epoch
    ds_read2_b32 v[8:9], v156 offset0:64 offset1:66
    ds_read_b128 v[128:131], v154 offset:10560
    ds_read_b128 v[132:135], v154 offset:11168
    ds_read_b128 v[136:139], v154 offset:11776
    ds_read_b128 v[140:143], v154 offset:12384
    ds_read_b128 v[112:115], v154 offset:10240
    ds_read_b128 v[116:119], v154 offset:10848
    ds_read_b128 v[120:123], v154 offset:11456
    ds_read_b128 v[124:127], v154 offset:12064
    ds_read_u16 v160, v159 offset:512
    s_waitcnt lgkmcnt(9)
    v_add_f32_dpp v8, v8, v8 quad_perm:[1,0,3,2] row_mask:0xf bank_mask:0xf
    v_add_f32_dpp v9, v9, v9 quad_perm:[1,0,3,2] row_mask:0xf bank_mask:0xf
    s_waitcnt lgkmcnt(7)
    v_pk_add_f32 v[128:129], v[128:129], v[132:133]
    v_add_f32_dpp v8, v8, v8 quad_perm:[2,3,0,1] row_mask:0xf bank_mask:0xf
    v_add_f32_dpp v9, v9, v9 quad_perm:[2,3,0,1] row_mask:0xf bank_mask:0xf
    v_pk_add_f32 v[130:131], v[130:131], v[134:135]
    s_waitcnt lgkmcnt(5)
    v_add_f32_dpp v8, v8, v8 row_half_mirror row_mask:0xf bank_mask:0xf
    v_add_f32_dpp v9, v9, v9 row_half_mirror row_mask:0xf bank_mask:0xf
    v_pk_add_f32 v[136:137], v[136:137], v[140:141]
    v_add_f32_dpp v8, v8, v8 row_mirror row_mask:0xf bank_mask:0xf
    v_add_f32_dpp v9, v9, v9 row_mirror row_mask:0xf bank_mask:0xf
    v_pk_add_f32 v[138:139], v[138:139], v[142:143]
    v_mul_f32 v10, 0x3b000000, v9
    v_mul_f32 v8, 0x3b000000, v8
    v_pk_add_f32 v[128:129], v[128:129], v[136:137]
    v_pk_add_f32 v[130:131], v[130:131], v[138:139]
    v_fma_f32 v8, -v10, v10, v8
    v_max_f32 v8, 0, v8
    v_cvt_pk_bf16_f32 v8, v8, v10
    s_waitcnt lgkmcnt(3)
    v_pk_add_f32 v[112:113], v[112:113], v[116:117]
    v_pk_add_f32 v[114:115], v[114:115], v[118:119]
    v_and_b32 v10, 0xffff0000, v8
    v_lshlrev_b32 v8, 16, v8
    v_add_f32 v8, 0x3727c5ac, v8
    v_cvt_pk_bf16_f32 v8, v8, v8
    v_lshlrev_b32 v8, 16, v8
    v_sqrt_f32 v8, v8
    s_waitcnt lgkmcnt(1)
    v_pk_add_f32 v[120:121], v[120:121], v[124:125]
    v_pk_add_f32 v[122:123], v[122:123], v[126:127]
    v_pk_fma_f32 v[112:113], v[128:129], v[10:11], v[112:113] op_sel_hi:[1,0,1] neg_lo:[0,1,0] neg_hi:[0,1,0]
    v_pk_fma_f32 v[114:115], v[130:131], v[10:11], v[114:115] op_sel_hi:[1,0,1] neg_lo:[0,1,0] neg_hi:[0,1,0]
    v_pk_add_f32 v[112:113], v[112:113], v[120:121]
    v_pk_add_f32 v[114:115], v[114:115], v[122:123]
    v_cvt_pk_bf16_f32 v8, v8, v8
    v_lshlrev_b32 v8, 16, v8
    v_add_f32_dpp v112, v112, v112 row_ror:4 row_mask:0xf bank_mask:0xf
    v_add_f32_dpp v113, v113, v113 row_ror:4 row_mask:0xf bank_mask:0xf
    v_add_f32_dpp v114, v114, v114 row_ror:4 row_mask:0xf bank_mask:0xf
    v_add_f32_dpp v115, v115, v115 row_ror:4 row_mask:0xf bank_mask:0xf
    v_rcp_f32 v8, v8
    v_add_f32_dpp v112, v112, v112 row_ror:8 row_mask:0xf bank_mask:0xf
    v_add_f32_dpp v113, v113, v113 row_ror:8 row_mask:0xf bank_mask:0xf
    v_add_f32_dpp v114, v114, v114 row_ror:8 row_mask:0xf bank_mask:0xf
    v_add_f32_dpp v115, v115, v115 row_ror:8 row_mask:0xf bank_mask:0xf
    v_pk_mul_f32 v[112:113], v[112:113], v[8:9] op_sel_hi:[1,0]
    v_pk_mul_f32 v[114:115], v[114:115], v[8:9] op_sel_hi:[1,0]
    v_pk_mul_f32 v[116:117], v[112:113], s[66:67]
    v_exp_f32 v116, v116
    v_exp_f32 v117, v117
    v_pk_mul_f32 v[112:113], v[112:113], v[114:115]
    v_pk_add_f32 v[116:117], v[116:117], 1.0 op_sel_hi:[1,0]
    v_rcp_f32 v116, v116
    v_rcp_f32 v117, v117
    s_nop 0
    v_pk_mul_f32 v[112:113], v[112:113], v[116:117]
    v_cvt_pk_bf16_f32 v20, v112, v113
    s_nop 1
    v_mov_b32_dpp v24, v20 row_newbcast:0 row_mask:0xf bank_mask:0x1
    v_mov_b32_dpp v25, v20 row_newbcast:1 row_mask:0xf bank_mask:0x1
    v_mov_b32_dpp v26, v20 row_newbcast:2 row_mask:0xf bank_mask:0x1
    v_mov_b32_dpp v27, v20 row_newbcast:3 row_mask:0xf bank_mask:0x1
    v_mov_b32_dpp v28, v20 row_newbcast:0 row_mask:0xf bank_mask:0x2
    v_mov_b32_dpp v29, v20 row_newbcast:1 row_mask:0xf bank_mask:0x2
    v_mfma_f32_16x16x32_bf16 v[16:19], v[24:27], v[48:51], 0
    v_mov_b32_dpp v30, v20 row_newbcast:2 row_mask:0xf bank_mask:0x2
    v_mov_b32_dpp v31, v20 row_newbcast:3 row_mask:0xf bank_mask:0x2
    v_mfma_f32_16x16x32_bf16 v[12:15], v[24:27], v[52:55], 0
    v_mov_b32_dpp v32, v20 row_newbcast:0 row_mask:0xf bank_mask:0x4
    v_mov_b32_dpp v33, v20 row_newbcast:1 row_mask:0xf bank_mask:0x4
    v_mfma_f32_16x16x32_bf16 v[16:19], v[28:31], v[56:59], v[16:19]
    v_mov_b32_dpp v34, v20 row_newbcast:2 row_mask:0xf bank_mask:0x4
    v_mov_b32_dpp v35, v20 row_newbcast:3 row_mask:0xf bank_mask:0x4
    v_mfma_f32_16x16x32_bf16 v[12:15], v[28:31], v[60:63], v[12:15]
    v_mov_b32_dpp v36, v20 row_newbcast:0 row_mask:0xf bank_mask:0x8
    v_mov_b32_dpp v37, v20 row_newbcast:1 row_mask:0xf bank_mask:0x8
    v_mfma_f32_16x16x32_bf16 v[16:19], v[32:35], v[64:67], v[16:19]
    v_mov_b32_dpp v38, v20 row_newbcast:2 row_mask:0xf bank_mask:0x8
    v_mov_b32_dpp v39, v20 row_newbcast:3 row_mask:0xf bank_mask:0x8
    v_mfma_f32_16x16x32_bf16 v[12:15], v[32:35], v[68:71], v[12:15]
    s_nop 0
    v_mfma_f32_16x16x32_bf16 v[16:19], v[36:39], v[72:75], v[16:19]
    v_mfma_f32_16x16x32_bf16 v[12:15], v[36:39], v[76:79], v[12:15]
    s_cmp_ge_u32 s68, 32
    s_nop 6
    v_bfi_b32 v17, v164, s92, v12
    buffer_store_dwordx2 v[16:17], v155, s[48:51], s78 offen sc1
    s_cbranch_scc1 L_exit
    v_mov_b32 v88, 0
    v_mov_b32 v90, 0
    s_waitcnt lgkmcnt(0)
    v_lshlrev_b32 v160, 16, v160
    s_waitcnt vmcnt(0)
L_poll_d:
    s_sleep 3
    buffer_load_dwordx4 v[80:83], v158, s[48:51], s60 offen sc1
    buffer_load_dwordx4 v[84:87], v158, s[48:51], s61 offen sc1
    v_mov_b32 v89, s92
    v_mov_b32 v91, s92
    s_mov_b32 exec_hi, 0xfff
    buffer_load_dwordx4 v[88:91], v158, s[48:51], s62 offen sc1
    s_mov_b32 exec_hi, -1
    s_sub_u32 s7, s7, 1
    s_cbranch_scc1 L_exit
    s_waitcnt vmcnt(0)
    v_xor_b32 v81, s92, v81
    v_xor_b32 v83, s92, v83
    v_xor_b32 v85, s92, v85
    v_xor_b32 v87, s92, v87
    v_xor_b32 v89, s92, v89
    v_xor_b32 v91, s92, v91
    v_or3_b32 v3, v81, v83, v85
    v_or3_b32 v3, v3, v87, v89
    v_or_b32 v3, v3, v91
    v_cmp_ne_u32_sdwa vcc, v3, v165 src0_sel:BYTE_0 src1_sel:DWORD
    v_pk_add_f32 v[80:81], v[80:81], v[84:85]
    v_pk_add_f32 v[82:83], v[82:83], v[86:87]
    v_pk_add_f32 v[80:81], v[80:81], v[88:89]
    v_pk_add_f32 v[82:83], v[82:83], v[90:91]
    s_cbranch_vccnz L_poll_d
    s_nop 0
    v_permlane32_swap_b32 v80, v82
    v_permlane32_swap_b32 v81, v83
    v_pk_add_f32 v[80:81], v[80:81], v[82:83]
    s_nop 1
    v_permlane16_swap_b32 v80, v81
    v_add_f32 v80, v80, v81
    s_nop 1
    v_add_f32_dpp v80, v80, v80 row_ror:4 row_mask:0xf bank_mask:0xf
    s_nop 1
    v_add_f32_dpp v80, v80, v80 row_ror:8 row_mask:0xf bank_mask:0xf
    s_mov_b32 exec_lo, 0x000f000f
    s_mov_b32 exec_hi, 0x000f000f
    v_add_f32 v80, v80, v160
    v_cvt_pk_bf16_f32 v80, v80, v80
    buffer_store_short v80, v159, s[52:55], 0 offen
L_exit:
L_end:
    s_endpgm
L_epoch:
    s_lshl3_add_u32 s76, s80, s5
    s_cmp_lg_u32 s76, 4
    s_cbranch_scc1 L_exit
    s_mov_b32 s76, 557060
    v_mov_b32 v3, s19
    s_mov_b64 exec, 1
    buffer_store_dword v3, off, s[48:51], s76 sc1
L_last:
    s_branch L_exit
.section .rodata,"a"
.p2align 6
.amdhsa_kernel sequential_preLN__sliding_block_cached__swiglu_ffn__decode_kernel
  .amdhsa_next_free_vgpr 168
  .amdhsa_next_free_sgpr 95
  .amdhsa_accum_offset 168
  .amdhsa_group_segment_fixed_size 0
  .amdhsa_kernarg_size 96
  .amdhsa_user_sgpr_count 2
  .amdhsa_user_sgpr_kernarg_segment_ptr 1
  .amdhsa_system_sgpr_workgroup_id_x 1
  .amdhsa_float_denorm_mode_32 3
.end_amdhsa_kernel
```
